```python
import torch

def _softmax(x, axis=-1):
    return torch.softmax(x, dim=axis)
def _gelu(x):
    return torch.nn.functional.gelu(x, approximate="tanh")
def _silu(x):
    return torch.nn.functional.silu(x)
def _sigmoid(x):
    return torch.sigmoid(x)
def _layernorm(x, axis=-1, eps=1e-5):
    m = x.mean(dim=axis, keepdim=True)
    v = x.var(dim=axis, keepdim=True, unbiased=False)
    return (x - m) / torch.sqrt(v + eps)
def _scatter_add(tgt, idx, src, axis=0):
    return tgt.clone().index_add_(axis, idx, src)
def _segment_sum(src, seg, n):
    out = torch.zeros((n,) + src.shape[1:], dtype=src.dtype)
    return out.index_add_(0, seg, src)
def _pad(x, pw):
    flat = tuple(v for pair in reversed(pw) for v in pair)
    return torch.nn.functional.pad(x, flat)

kernel_name = 'recurrent_scan__ssm_conv_h3__dense_activation_silu__prompt'

def setup_inputs():

    _w = (lambda a: (lambda t: t.to(torch.bfloat16) if t.is_floating_point() else t)(torch.as_tensor(a)))
    def _A_setup():
        B, S, D = 1, 2048, 512
        ks = 4
        return {
            "q": _w((lambda *s: torch.randn(*s, dtype=torch.bfloat16) * 0.05)(B, S, D)),
            "k": _w((lambda *s: torch.randn(*s, dtype=torch.bfloat16) * 0.8)(B, S, D)),
            "v": _w((lambda *s: torch.randn(*s, dtype=torch.bfloat16) * 0.8)(B, S, D)),
            "shift_k": _w((lambda *s: torch.randn(*s, dtype=torch.bfloat16) * 0.8)(D, ks) * 0.5),
            "ssm_k": _w((lambda *s: torch.randn(*s, dtype=torch.bfloat16) * 0.8)(D, S) * (1.0 / S ** 0.5)),
            "ssm_D": _w((lambda *s: torch.randn(*s, dtype=torch.bfloat16) * 0.8)(D)),
        }
    _A_in = _A_setup()

    def _B_setup():
        B, S, D, F = 1, 2048, 512, 1792
        return {
            "x": _w((lambda *s: torch.randn(*s, dtype=torch.bfloat16) * 0.05)(B, S, D)),
            "w1": _w((lambda *s: torch.randn(*s, dtype=torch.bfloat16) * 0.8)(D, F) * (D ** -0.5)),
            "w2": _w((lambda *s: torch.randn(*s, dtype=torch.bfloat16) * 0.2)(F, D) * (F ** -0.5)),
        }
    _B_in = _B_setup()

    return {
        "A_q": _A_in["q"],
        "A_k": _A_in["k"],
        "A_v": _A_in["v"],
        "A_shift_k": _A_in["shift_k"],
        "A_ssm_k": _A_in["ssm_k"],
        "A_ssm_D": _A_in["ssm_D"],
        "B_x": _B_in["x"],
        "B_w1": _B_in["w1"],
        "B_w2": _B_in["w2"],
    }

def reference(A_q, A_k, A_v, A_shift_k, A_ssm_k, A_ssm_D, B_x, B_w1, B_w2):
    def _A_ref(q, k, v, shift_k, ssm_k, ssm_D):
        B, S, D = q.shape
        ks = shift_k.shape[-1]
        k_pad = _pad(k, ((0, 0), (ks - 1, 0), (0, 0)))
        k_shift = torch.zeros_like(k)
        for t in range(ks):
            k_shift = k_shift + k_pad[:, t:t + S, :] * shift_k[:, ks - 1 - t][None, None, :]
        kv = k_shift * v
        L = 2 * S
        kv_pad = _pad(kv, ((0, 0), (0, S), (0, 0)))
        kf_pad = _pad(ssm_k, ((0, 0), (0, S)))
        kv_f = (lambda x, axes=(-2,-1): torch.fft.rfft2(x.float(), dim=axes))(kv_pad[:, None, :, :], axes=(1, 2))
        kf_f = (lambda x, axes=(-2,-1): torch.fft.rfft2(x.float(), dim=axes))(kf_pad[:, None, :], axes=(1, 2))
        kf_f = (lambda x, *d: x.permute(*d))(kf_f, 1, 2, 0)
        y_f = kv_f * kf_f[None, :, :, :]
        y = (lambda x, s, axes=(-2,-1): torch.fft.irfft2(x, s=s, dim=axes).to(torch.bfloat16))(y_f, (1, L), axes=(1, 2))[:, 0, :S, :]
        y = y + kv * ssm_D[None, None, :]
        return q * y

    def _B_ref(x, w1, w2):
        h = torch.einsum("bsd,df->bsf", x, w1)
        h = _silu(h)
        out = torch.einsum("bsf,fd->bsd", h, w2)
        return out

    x = A_q
    xn = _layernorm(x, axis=-1)
    s = _A_ref(xn, A_k, A_v, A_shift_k, A_ssm_k, A_ssm_D)
    g = _silu(_B_ref(xn, B_w1, B_w2))
    return x + s * g
```

```asm
; @launch grid=(256,1,1) block=(256,1,1) lds=163840
.amdgcn_target "amdgcn-amd-amdhsa--gfx950"
.text
.globl recurrent_scan__ssm_conv_h3__dense_activation_silu__prompt_kernel
.p2align 8
.type recurrent_scan__ssm_conv_h3__dense_activation_silu__prompt_kernel,@function
recurrent_scan__ssm_conv_h3__dense_activation_silu__prompt_kernel:
    s_load_dwordx16 s[64:79], s[0:1], 0
    s_load_dwordx8 s[80:87], s[0:1], 64
    s_memrealtime s[40:41]
    s_cmp_ge_u32 s2, 256
    s_cbranch_scc1 L_end
    v_lshrrev_b32 v63, 6, v0
    v_and_b32 v1, 63, v0
    s_and_b32 s3, s2, 7
    v_readfirstlane_b32 s5, v63
    s_lshr_b32 s4, s2, 3
    s_lshr_b32 s98, s4, 1
    s_and_b32 s6, s4, 1
    s_lshl_b32 s97, s3, 1
    s_add_u32 s97, s97, s6
    s_mul_i32 s6, s6, 0
    s_add_u32 s6, s6, s98
    s_add_u32 s6, s6, s3
    s_and_b32 s6, s6, 7
    s_mov_b32 s14, 0x200000
    s_mov_b32 s15, 0x20000
    s_cmp_lt_u32 s98, 14
    s_cselect_b32 s10, 0x200000, 0
    s_cselect_b32 s26, 1835008, 0
    s_mov_b32 s11, 0x20000
    s_mov_b32 s27, 0x20000
    s_lshl_b32 s88, s3, 5
    s_add_u32 s88, s88, s4
    s_lshl_b32 s88, s88, 2
    s_add_u32 s88, s88, s5
    s_lshl_b32 s88, s88, 11
    s_lshl_b32 s89, s97, 2
    s_add_u32 s89, s89, s5
    s_lshl_b32 s89, s89, 15
    s_mul_i32 s90, s5, 57344
    s_lshl_b32 s7, s98, 8
    s_add_u32 s90, s90, s7
    s_and_b32 s59, s4, 1
    s_mul_i32 s59, s59, 0
    s_add_u32 s59, s59, s6
    s_and_b32 s59, s59, 7
    s_lshl_b32 s58, s59, 7
    s_add_u32 s58, s58, s89
    s_mul_i32 s59, s59, 229376
    s_add_u32 s59, s59, s90
    s_lshl_b32 s92, s5, 12
    s_add_u32 s93, s92, 16384
    s_lshr_b32 s7, s4, 3
    s_lshl_b32 s99, s3, 2
    s_add_u32 s99, s99, s7
    s_and_b32 s100, s4, 7
    s_lshl_b32 s42, s5, 3
    s_or_b32 s42, s42, s2
    s_getpc_b64 s[16:17]
L_pc:
    s_mov_b32 s18, L_codeend-L_pc
    s_mov_b32 s19, 0x20000
    s_lshl_b32 s20, s4, 2
    s_add_u32 s20, s20, s5
    s_lshl_b32 s20, s20, 8
    v_lshlrev_b32 v238, 2, v1
    buffer_load_dword a252, v238, s[16:19], s20 offen
    v_lshlrev_b32 v2, 4, v1
    v_lshrrev_b32 v232, 5, v1
    v_and_b32 v233, 31, v1
    v_lshlrev_b32 v233, 4, v233
    v_lshl_add_u32 v236, v232, 10, v233
    v_lshrrev_b32 v232, 3, v1
    v_and_b32 v233, 7, v1
    v_lshrrev_b32 v234, 4, v1
    v_xor_b32 v235, v233, v234
    v_lshlrev_b32_e64 v235, 4, v235
    v_lshl_add_u32 v4, v232, 10, v235
    v_xor_b32_e64 v235, 64, v4
    v_add_u32 v5, 7168, v235
    v_add_u32 v6, 14336, v4
    v_add_u32 v7, 21504, v235
    v_and_b32 v235, 15, v1
    v_lshlrev_b32 v237, 2, v234
    v_xor_b32 v235, v235, v237
    v_lshlrev_b32 v235, 4, v235
    v_mul_u32_u24 v237, 3584, v234
    v_add_u32_e64 v8, v237, v235
    v_add_u32 v9, 13312, v8
    v_add_u32 v10, 26624, v8
    v_add_u32 v11, 39936, v8
    v_lshlrev_b32_e64 v233, 4, v233
    v_lshl_add_u32 v237, v232, 10, v233
    v_lshlrev_b32 v238, 4, v232
    s_lshl_b32 s43, s100, 2
    s_add_u32 s43, s43, s5
    s_lshl_b32 s43, s43, 7
    v_add_u32 v238, s43, v238
    s_lshl_b32 s43, s2, 2
    v_mov_b32 v240, s43
    s_lshr_b32 s43, s5, 1
    s_lshl_b32 s43, s43, 12
    s_lshl_b32 s91, s2, 13
    s_add_u32 s43, s43, s91
    v_mov_b32 v241, s43
    v_mov_b32 v242, 0
    v_min_u32 v243, 5, v1
    v_lshlrev_b32_e64 v243, 21, v243
    s_mov_b32 s30, 1835008
    s_mov_b32 s34, 2097152
    s_mov_b32 s38, 12582912
    s_mov_b32 s46, 2097152
    s_mov_b32 s50, 256
    s_mov_b32 s31, 0x20000
    s_mov_b32 s35, 0x20000
    s_mov_b32 s39, 0x20000
    s_mov_b32 s47, 0x20000
    s_mov_b32 s51, 0x20000
    s_waitcnt lgkmcnt(0)
    s_cmp_gt_u32 s42, 7
    s_cbranch_scc1 L_nonce_done
    s_or_b32 s40, s40, 1
    v_mov_b32 v245, 0
    v_mov_b32 v244, s40
    s_mov_b64 exec, 1
    global_atomic_cmpswap v245, v[244:245], s[84:85] sc1
    s_mov_b64 exec, -1
L_nonce_done:
    global_load_dwordx4 v[228:231], v238, s[70:71]
    global_load_dword a248, v240, s[74:75]
    global_load_dword a249, v241, s[72:73]
    global_load_dword a230, v242, s[66:67]
    global_load_dword a231, v242, s[68:69]
    s_mov_b64 s[12:13], s[64:65]
    s_mov_b64 s[8:9], s[64:65]
    s_mov_b64 s[24:25], s[78:79]
    buffer_load_dwordx4 v[220:223], v236, s[12:15], s88 offen nt
    buffer_load_dwordx4 v[224:227], v236, s[12:15], s88 offen offset:512 nt
    s_add_u32 m0, s92, 0
    s_nop 0
    buffer_load_dwordx4 v4, s[8:11], s58 offen lds
    buffer_load_dwordx4 v5, s[8:11], s58 offen offset:1024 lds
    buffer_load_dwordx4 v6, s[8:11], s58 offen offset:2048 lds
    buffer_load_dwordx4 v7, s[8:11], s58 offen offset:3072 lds
    s_add_u32 m0, s93, 0
    s_nop 0
    buffer_load_dwordx4 v8, s[24:27], s59 offen lds
    buffer_load_dwordx4 v9, s[24:27], s59 offen offset:1024 lds
    buffer_load_dwordx4 v10, s[24:27], s59 offen offset:2048 lds
    buffer_load_dwordx4 v11, s[24:27], s59 offen offset:3072 lds
    s_mov_b64 s[16:17], s[66:67]
    s_mov_b64 s[60:61], s[66:67]
    s_mov_b64 s[20:21], s[68:69]
    s_mov_b64 s[52:53], s[70:71]
    s_mov_b64 s[32:33], s[72:73]
    s_mov_b64 s[56:57], s[74:75]
    s_mov_b64 s[28:29], s[80:81]
    s_mov_b64 s[44:45], s[82:83]
    s_mov_b64 s[48:49], s[84:85]
    s_mov_b64 s[36:37], s[86:87]
    s_and_b32 s7, s4, 0
    s_mul_i32 s7, s7, 0
    s_xor_b32 s7, s7, 1
    s_add_u32 s7, s7, s6
    s_and_b32 s7, s7, 7
    s_lshl_b32 s65, s7, 7
    s_add_u32 s65, s65, s89
    s_mul_i32 s73, s7, 229376
    s_add_u32 s73, s73, s90
    s_and_b32 s7, s4, 0
    s_mul_i32 s7, s7, 0
    s_xor_b32 s7, s7, 2
    s_add_u32 s7, s7, s6
    s_and_b32 s7, s7, 7
    s_lshl_b32 s66, s7, 7
    s_add_u32 s66, s66, s89
    s_mul_i32 s74, s7, 229376
    s_add_u32 s74, s74, s90
    s_and_b32 s7, s4, 0
    s_mul_i32 s7, s7, 0
    s_xor_b32 s7, s7, 3
    s_add_u32 s7, s7, s6
    s_and_b32 s7, s7, 7
    s_lshl_b32 s67, s7, 7
    s_add_u32 s67, s67, s89
    s_mul_i32 s75, s7, 229376
    s_add_u32 s75, s75, s90
    s_and_b32 s7, s4, 0
    s_mul_i32 s7, s7, 0
    s_add_u32 m0, s92, 32768
    s_nop 0
    buffer_load_dwordx4 v4, s[8:11], s65 offen lds
    s_xor_b32 s7, s7, 4
    s_add_u32 s7, s7, s6
    s_and_b32 s7, s7, 7
    s_lshl_b32 s68, s7, 7
    s_add_u32 s68, s68, s89
    s_mul_i32 s76, s7, 229376
    s_add_u32 s76, s76, s90
    s_and_b32 s7, s4, 0
    s_mul_i32 s7, s7, 0
    s_xor_b32 s7, s7, 5
    s_add_u32 s7, s7, s6
    s_and_b32 s7, s7, 7
    s_lshl_b32 s69, s7, 7
    s_add_u32 s69, s69, s89
    s_mul_i32 s77, s7, 229376
    s_add_u32 s77, s77, s90
    s_and_b32 s7, s4, 0
    s_mul_i32 s7, s7, 0
    s_xor_b32 s7, s7, 6
    s_add_u32 s7, s7, s6
    s_and_b32 s7, s7, 7
    s_lshl_b32 s70, s7, 7
    s_add_u32 s70, s70, s89
    s_mul_i32 s78, s7, 229376
    s_add_u32 s78, s78, s90
    s_and_b32 s7, s4, 0
    s_mul_i32 s7, s7, 0
    s_xor_b32 s7, s7, 7
    s_add_u32 s7, s7, s6
    s_and_b32 s7, s7, 7
    s_lshl_b32 s71, s7, 7
    s_add_u32 s71, s71, s89
    s_mul_i32 s79, s7, 229376
    s_add_u32 s79, s79, s90
    s_and_b32 s85, s5, 1
    s_lshr_b32 s86, s5, 1
    s_lshl_b32 s101, s2, 1
    s_add_u32 s101, s101, s86
    s_lshl_b32 s80, s5, 13
    s_mul_i32 s81, s5, 458752
    s_lshl_b32 s6, s100, 7
    s_add_u32 s81, s81, s6
    s_lshr_b32 s83, s4, 3
    s_mul_i32 s83, s83, 2
    s_add_u32 s83, s83, s100
    s_mul_i32 s6, s3, 1
    s_add_u32 s83, s83, s6
    s_mul_i32 s6, s83, 37
    s_lshr_b32 s6, s6, 8
    s_mul_i32 s6, s6, 7
    s_sub_u32 s83, s83, s6
    s_lshl_b32 s6, s83, 16
    s_add_u32 s81, s81, s6
    s_lshl_b32 s82, s97, 1
    s_add_u32 s82, s82, s86
    s_mul_i32 s88, s82, 229376
    s_lshl_b32 s82, s82, 10
    s_add_u32 s82, s82, 11534336
    s_lshl_b32 s6, s98, 1
    s_add_u32 s6, s6, s85
    s_lshl_b32 s6, s6, 12
    s_add_u32 s88, s88, s6
    s_lshl_b32 s6, s86, 11
    s_xor_b32 s7, s6, 2048
    s_add_u32 s90, s88, s7
    s_add_u32 s88, s88, s6
    s_add_u32 s89, s88, 114688
    s_add_u32 s91, s90, 114688
    s_lshl_b32 s84, s3, 5
    s_add_u32 s84, s84, s4
    s_lshl_b32 s84, s84, 7
    s_lshl_b32 s6, s5, 4
    s_add_u32 s84, s84, s6
    s_add_u32 s84, s84, 11534336
    v_mov_b32 v244, 2147483648
    v_cmp_eq_u32 vcc, 0, v1
    v_and_b32 v245, 31, v1
    v_lshrrev_b32 v246, 5, v1
    v_cndmask_b32 v3, v244, 0, vcc
    v_lshrrev_b32 v247, 3, v245
    v_and_b32 v248, 7, v1
    v_lshlrev_b32_e64 v248, 3, v248
    v_lshl_add_u32 v29, v247, 7, v248
    v_lshrrev_b32 v247, 1, v245
    v_and_b32 v247, 7, v247
    v_xor_b32 v247, v247, v246
    v_lshlrev_b32 v247, 4, v247
    v_lshl_add_u32 v247, v245, 7, v247
    s_lshl_b32 s6, s86, 13
    v_add_u32 v16, s6, v247
    v_xor_b32 v17, 32, v16
    v_xor_b32 v18, 64, v16
    v_xor_b32 v19, 0x60, v16
    v_add_u32 v20, 0x10000, v16
    v_add_u32 v21, 0x10000, v17
    v_add_u32 v22, 0x10000, v18
    v_add_u32 v23, 0x10000, v19
    v_bfe_u32 v247, v1, 2, 2
    v_and_b32 v248, 3, v1
    v_lshlrev_b32 v248, 3, v248
    v_bfe_u32 v249, v1, 4, 1
    v_lshl_add_u32 v248, v249, 5, v248
    s_lshl_b32 s6, s85, 1
    s_add_u32 s6, s6, s86
    v_xor_b32_e64 v249, s6, v247
    v_lshl_add_u32 v249, v249, 6, v248
    v_lshl_add_u32 v249, v247, 8, v249
    v_lshl_add_u32 v24, v246, 11, v249
    v_xor_b32_e64 v25, 64, v24
    v_add_u32 v26, 0x10000, v24
    v_add_u32 v27, 0x10000, v25
    v_lshrrev_b32 v249, 1, v247
    v_xor_b32 v249, s85, v249
    v_lshl_add_u32 v249, v249, 6, v248
    v_lshl_add_u32 v249, v247, 7, v249
    v_lshl_add_u32 v249, v246, 9, v249
    v_add_u32 v33, s80, v249
    v_xor_b32 v34, 64, v33
    v_add_u32 v35, 0x10000, v33
    v_add_u32 v36, 0x10000, v34
    v_lshl_add_u32 v249, v247, 6, v248
    v_lshl_add_u32 v249, v246, 8, v249
    s_add_u32 s6, s80, 133120
    v_add_u32 v55, s6, v249
    v_add_u32 v54, s6, v2
    v_and_b32 v247, 15, v1
    v_lshrrev_b32 v248, 4, v1
    v_and_b32 v249, 1, v248
    v_cmp_eq_u32 vcc, v247, v249
    v_mov_b32 v249, 0x3f803f80
    v_lshlrev_b32 v244, 4, v248
    v_cndmask_b32 v249, 0, v249, vcc
    v_lshl_add_u32 v244, v247, 6, v244
    v_accvgpr_write_b32 a240, v249
    v_accvgpr_write_b32 a241, v249
    v_accvgpr_write_b32 a242, v249
    v_accvgpr_write_b32 a243, v249
    s_lshl_b32 s6, s85, 8
    s_lshl_b32 s7, s86, 7
    s_add_u32 s6, s6, s7
    s_add_u32 s6, s6, 157968
    v_add_u32 v244, s6, v244
    v_add_u32 v249, 158480, v2
    v_cmp_gt_u32 vcc, 2, v247
    v_lshlrev_b32 v245, 4, v246
    v_add_u32 v31, s6, v245
    v_cndmask_b32 v30, v249, v244, vcc
    v_xor_b32 v32, 0x80, v31
    v_lshrrev_b32 v244, 3, v1
    v_and_b32 v245, 7, v1
    v_bfe_u32 v249, v1, 4, 1
    v_lshlrev_b32 v249, 2, v249
    v_xor_b32 v245, v245, v249
    v_lshlrev_b32_e64 v245, 4, v245
    v_lshl_add_u32 v12, v244, 10, v245
    v_add_u32 v13, 7168, v12
    v_add_u32 v14, 14336, v12
    v_add_u32 v15, 21504, v12
    v_lshlrev_b32_e64 v244, 1, v247
    v_lshl_add_u32 v244, v248, 4, v244
    v_and_b32 v245, 1, v247
    v_cmp_eq_u32 vcc, 0, v245
    v_mov_b32 v249, 4158
    s_mul_i32 s6, s86, 8320
    s_lshl_b32 s7, s85, 6
    v_cndmask_b32 v245, 0, v249, vcc
    s_add_u32 s6, s6, s7
    s_add_u32 s6, s6, 131074
    v_add3_u32 v37, v244, v245, s6
    v_add_u32 v38, 1024, v37
    v_add_u32 v39, 2048, v37
    v_add_u32 v40, 3072, v37
    s_mul_i32 s6, s86, 4608
    s_add_u32 s6, s6, 148752
    v_lshlrev_b32 v244, 5, v247
    v_lshlrev_b32 v245, 4, v248
    v_sub_u32 v245, v245, v244
    s_add_u32 s7, s7, s6
    s_add_u32 s7, s7, 480
    v_add_u32 v41, s7, v245
    v_lshl_add_u32 v245, v248, 3, v244
    s_lshl_b32 s7, s85, 11
    s_sub_u32 s96, s6, s7
    s_add_u32 s96, s96, 2552
    v_sub_u32 v43, s96, v245
    s_add_u32 s7, s7, s6
    v_add_u32_e64 v42, s7, v2
    v_and_b32 v245, 0x1f0, v2
    s_add_u32 s6, s6, 4096
    v_add_u32 v245, s6, v245
    v_mov_b32 v252, 0
    v_mov_b32 v253, 0
    v_mov_b32 v254, 0
    v_mov_b32_e64 v255, 0
    ds_write_b128 v245, v[252:255]
    s_add_u32 s6, s80, 98304
    v_add_u32_e64 v44, s6, v2
    v_xor_b32 v45, 0x2000, v44
    v_and_b32_e64 v245, 1, v248
    v_lshl_add_u32 v244, v245, 9, v244
    v_lshrrev_b32_e64 v245, 1, v248
    v_lshl_add_u32 v46, v245, 4, v244
    v_lshlrev_b32 v47, 2, v247
    v_min_u32 v244, 6, v1
    v_lshlrev_b32 v48, 2, v244
    v_and_b32 v244, 31, v1
    v_lshlrev_b32 v49, 2, v244
    v_lshrrev_b32 v245, 2, v1
    v_and_b32 v249, 3, v1
    v_lshlrev_b32 v249, 4, v249
    v_lshl_add_u32 v52, v245, 10, v249
    v_lshl_add_u32 v51, v245, 12, v249
    v_lshlrev_b32 v247, 4, v248
    v_xor_b32 v50, v52, v247
    v_mul_u32_u24 v245, 80, v245
    s_add_u32 s6, s80, 135168
    v_add3_u32 v57, v245, v249, s6
    v_mul_u32_u24 v245, 80, v244
    v_lshl_add_u32 v245, v246, 3, v245
    v_add_u32_e64 v56, s6, v245
    v_bfe_u32 v245, v1, 2, 2
    v_lshlrev_b32_e64 v245, 4, v245
    v_lshl_add_u32 v245, v244, 6, v245
    v_lshl_add_u32 v245, v246, 3, v245
    s_add_u32 s6, s80, 131072
    v_add_u32 v53, s6, v245
    v_add_u32 v58, s80, v2
    v_xor_b32 v59, 0x4000, v58
    v_xor_b32 v60, 0x6000, v58
    v_xor_b32 v61, 0x2000, v58
    s_cmp_lg_u32 s99, 0
    s_cselect_b32 s62, 0x200000, 0
    s_mov_b32 s63, 0x20000
    s_mov_b32 s18, 2097152
    s_mov_b32 s19, 0x20000
    s_mov_b32 s22, 2097152
    s_mov_b32 s23, 0x20000
    s_mov_b32 s54, 4096
    s_mov_b32 s55, 0x20000
    s_lshl_b32 s40, s99, 16
    s_lshl_b32 s41, s100, 7
    s_add_u32 s40, s40, s41
    s_lshl_b32 s41, s5, 13
    s_add_u32 s41, s41, s40
    s_add_u32 s42, s41, 32768
    s_sub_u32 s40, s40, 8192
    s_max_i32 s40, s40, 0
    s_mul_i32 s43, s5, 1040
    s_lshl_b32 s87, s100, 9
    s_lshl_b32 s7, s5, 7
    s_add_u32 s87, s87, s7
    v_cmp_gt_u32 vcc, 40, v1
    v_mov_b32 v239, 2147483648
    s_nop 0
    v_cndmask_b32 v239, v237, v239, vcc
    s_waitcnt vmcnt(10)
    v_lshlrev_b32_e64 v176, 16, v220
    v_and_b32 v177, 0xffff0000, v220
    v_lshlrev_b32_e64 v178, 16, v221
    v_and_b32 v179, 0xffff0000, v221
    v_lshlrev_b32_e64 v180, 16, v222
    v_and_b32 v181, 0xffff0000, v222
    v_lshlrev_b32_e64 v182, 16, v223
    v_and_b32 v183, 0xffff0000, v223
    s_waitcnt vmcnt(9)
    v_lshlrev_b32 v184, 16, v224
    v_and_b32 v185, 0xffff0000, v224
    v_lshlrev_b32_e64 v186, 16, v225
    v_and_b32 v187, 0xffff0000, v225
    v_lshlrev_b32_e64 v188, 16, v226
    v_and_b32 v189, 0xffff0000, v226
    v_lshlrev_b32_e64 v190, 16, v227
    v_and_b32 v191, 0xffff0000, v227
    v_pk_add_f32 v[200:201], v[176:177], v[178:179]
    v_pk_add_f32 v[202:203], v[180:181], v[182:183]
    v_pk_add_f32 v[204:205], v[184:185], v[186:187]
    v_pk_add_f32 v[206:207], v[188:189], v[190:191]
    v_pk_add_f32 v[200:201], v[200:201], v[202:203]
    v_pk_add_f32 v[204:205], v[204:205], v[206:207]
    v_pk_add_f32 v[200:201], v[200:201], v[204:205]
    buffer_load_dwordx4 v5, s[8:11], s65 offen offset:1024 lds
    v_add_f32 v192, v200, v201
    s_nop 1
    v_add_f32_dpp v192, v192, v192 quad_perm:[1,0,3,2] row_mask:0xf bank_mask:0xf
    s_nop 1
    v_add_f32_dpp v192, v192, v192 quad_perm:[2,3,0,1] row_mask:0xf bank_mask:0xf
    s_nop 1
    v_add_f32_dpp v192, v192, v192 row_half_mirror row_mask:0xf bank_mask:0xf
    s_nop 1
    v_add_f32_dpp v192, v192, v192 row_mirror row_mask:0xf bank_mask:0xf
    v_mov_b32 v194, v192
    s_nop 1
    v_permlane16_swap_b32 v192, v194
    buffer_load_dwordx4 v6, s[8:11], s65 offen offset:2048 lds
    v_add_f32_e64 v192, v192, v194
    v_mul_f32 v192, 0x3b000000, v192
    v_pk_add_f32 v[176:177], v[176:177], v[192:193] op_sel_hi:[1,0] neg_lo:[0,1] neg_hi:[0,1]
    v_pk_add_f32 v[178:179], v[178:179], v[192:193] op_sel_hi:[1,0] neg_lo:[0,1] neg_hi:[0,1]
    v_pk_add_f32 v[180:181], v[180:181], v[192:193] op_sel_hi:[1,0] neg_lo:[0,1] neg_hi:[0,1]
    v_pk_add_f32 v[182:183], v[182:183], v[192:193] op_sel_hi:[1,0] neg_lo:[0,1] neg_hi:[0,1]
    v_pk_add_f32 v[184:185], v[184:185], v[192:193] op_sel_hi:[1,0] neg_lo:[0,1] neg_hi:[0,1]
    buffer_load_dwordx4 v7, s[8:11], s65 offen offset:3072 lds
    v_pk_add_f32 v[186:187], v[186:187], v[192:193] op_sel_hi:[1,0] neg_lo:[0,1] neg_hi:[0,1]
    v_pk_add_f32 v[188:189], v[188:189], v[192:193] op_sel_hi:[1,0] neg_lo:[0,1] neg_hi:[0,1]
    v_pk_add_f32 v[190:191], v[190:191], v[192:193] op_sel_hi:[1,0] neg_lo:[0,1] neg_hi:[0,1]
    v_pk_mul_f32 v[200:201], v[176:177], v[176:177]
    v_pk_mul_f32 v[202:203], v[178:179], v[178:179]
    v_pk_fma_f32 v[200:201], v[180:181], v[180:181], v[200:201]
    v_pk_fma_f32 v[202:203], v[182:183], v[182:183], v[202:203]
    s_add_u32 m0, s93, 32768
    s_nop 0
    buffer_load_dwordx4 v8, s[24:27], s73 offen lds
    v_pk_fma_f32 v[200:201], v[184:185], v[184:185], v[200:201]
    v_pk_fma_f32 v[202:203], v[186:187], v[186:187], v[202:203]
    v_pk_fma_f32 v[200:201], v[188:189], v[188:189], v[200:201]
    v_pk_fma_f32 v[202:203], v[190:191], v[190:191], v[202:203]
    v_pk_add_f32 v[200:201], v[200:201], v[202:203]
    v_add_f32 v193, v200, v201
    s_nop 1
    v_add_f32_dpp v193, v193, v193 quad_perm:[1,0,3,2] row_mask:0xf bank_mask:0xf
    buffer_load_dwordx4 v9, s[24:27], s73 offen offset:1024 lds
    s_nop 0
    v_add_f32_dpp v193, v193, v193 quad_perm:[2,3,0,1] row_mask:0xf bank_mask:0xf
    s_nop 1
    v_add_f32_dpp v193, v193, v193 row_half_mirror row_mask:0xf bank_mask:0xf
    s_nop 1
    v_add_f32_dpp v193, v193, v193 row_mirror row_mask:0xf bank_mask:0xf
    v_mov_b32 v194, v193
    s_nop 1
    v_permlane16_swap_b32 v193, v194
    v_add_f32 v193, v193, v194
    v_mul_f32 v193, 0x3b000000, v193
    buffer_load_dwordx4 v10, s[24:27], s73 offen offset:2048 lds
    v_cvt_pk_bf16_f32 v193, v193, v193
    v_lshlrev_b32_e64 v193, 16, v193
    v_add_f32 v193, 0x3727c5ac, v193
    v_cvt_pk_bf16_f32 v193, v193, v193
    v_lshlrev_b32 v193, 16, v193
    v_sqrt_f32 v193, v193
    v_and_b32_e64 v194, 31, v1
    buffer_load_dwordx4 v11, s[24:27], s73 offen offset:3072 lds
    v_cvt_pk_bf16_f32 v196, v192, v193
    v_lshrrev_b32_e64 v192, 2, v1
    v_mov_b32 v193, 2147483648
    v_cmp_eq_u32 vcc, 0, v194
    s_nop 1
    v_cndmask_b32 v198, v193, v192, vcc
    s_add_u32 m0, s92, 65536
    s_nop 0
    buffer_load_dwordx4 v4, s[8:11], s66 offen lds
    buffer_load_dwordx4 v5, s[8:11], s66 offen offset:1024 lds
    buffer_load_dwordx4 v6, s[8:11], s66 offen offset:2048 lds
    buffer_load_dwordx4 v7, s[8:11], s66 offen offset:3072 lds
    s_cmp_ge_u32 s98, 14
    s_cbranch_scc1 L_spare1
    s_waitcnt vmcnt(12)
    s_barrier
    ds_read_b64_tr_b16 v[128:129], v24 offset:16384
    ds_read_b64_tr_b16 v[130:131], v24 offset:17408
    ds_read_b128 v[136:139], v16 offset:0
    ds_read_b128 v[140:143], v16 offset:4096
    ds_read_b64_tr_b16 v[132:133], v25 offset:16384
    ds_read_b64_tr_b16 v[134:135], v25 offset:17408
    ds_read_b64_tr_b16 v[144:145], v24 offset:20480
    ds_read_b64_tr_b16 v[146:147], v24 offset:21504
    ds_read_b128 v[152:155], v17 offset:0
    ds_read_b128 v[156:159], v17 offset:4096
    ds_read_b64_tr_b16 v[148:149], v25 offset:20480
    ds_read_b64_tr_b16 v[150:151], v25 offset:21504
    s_waitcnt lgkmcnt(9)
    v_mfma_f32_32x32x16_bf16 v[64:79], v[128:131], v[136:139], 0
    ds_read_b64_tr_b16 v[160:161], v24 offset:24576
    ds_read_b64_tr_b16 v[162:163], v24 offset:25600
    s_add_u32 m0, s93, 65536
    s_nop 0
    buffer_load_dwordx4 v8, s[24:27], s74 offen lds
    s_load_dword s58, s[48:49], 0
    v_mfma_f32_16x16x32_bf16 a[244:247], v[128:131], a[240:243], 0
    s_waitcnt lgkmcnt(10)
    v_mfma_f32_32x32x16_bf16 v[80:95], v[128:131], v[140:143], 0
    ds_read_b128 v[168:171], v18 offset:0
    ds_read_b128 v[172:175], v18 offset:4096
    buffer_load_dwordx4 v9, s[24:27], s74 offen offset:1024 lds
    s_waitcnt lgkmcnt(10)
    v_mfma_f32_32x32x16_bf16 v[96:111], v[132:135], v[136:139], 0
    ds_read_b64_tr_b16 v[164:165], v25 offset:24576
    ds_read_b64_tr_b16 v[166:167], v25 offset:25600
    v_mfma_f32_32x32x16_bf16 v[112:127], v[132:135], v[140:143], 0
    buffer_load_dwordx4 v10, s[24:27], s74 offen offset:2048 lds
    s_waitcnt lgkmcnt(6)
    v_mfma_f32_32x32x16_bf16 v[64:79], v[144:147], v[152:155], v[64:79]
    ds_read_b64_tr_b16 v[128:129], v24 offset:28672
    ds_read_b64_tr_b16 v[130:131], v24 offset:29696
    ds_read_b128 v[136:139], v19 offset:0
    v_mfma_f32_16x16x32_bf16 a[244:247], v[144:147], a[240:243], a[244:247]
    buffer_load_dwordx4 v11, s[24:27], s74 offen offset:3072 lds
    v_mfma_f32_32x32x16_bf16 v[80:95], v[144:147], v[156:159], v[80:95]
    ds_read_b128 v[140:143], v19 offset:4096
    ds_read_b64_tr_b16 v[132:133], v25 offset:28672
    ds_read_b64_tr_b16 v[134:135], v25 offset:29696
    v_mfma_f32_32x32x16_bf16 v[96:111], v[148:151], v[152:155], v[96:111]
    s_waitcnt vmcnt(8)
    s_waitcnt lgkmcnt(0)
    v_mfma_f32_32x32x16_bf16 v[112:127], v[148:151], v[156:159], v[112:127]
    s_barrier
    s_add_u32 m0, s43, 132112
    s_nop 0
    buffer_load_dwordx4 v237, s[16:19], s41 offen nt lds
    v_mfma_f32_32x32x16_bf16 v[64:79], v[160:163], v[168:171], v[64:79]
    ds_read_b64_tr_b16 v[144:145], v24 offset:49152
    ds_read_b64_tr_b16 v[146:147], v24 offset:50176
    v_mfma_f32_16x16x32_bf16 a[244:247], v[160:163], a[240:243], a[244:247]
    s_add_u32 m0, s43, 140432
    s_nop 0
    buffer_load_dwordx4 v237, s[20:23], s41 offen nt lds
    v_mfma_f32_32x32x16_bf16 v[80:95], v[160:163], v[172:175], v[80:95]
    ds_read_b128 v[152:155], v16 offset:32768
    ds_read_b128 v[156:159], v16 offset:36864
    s_waitcnt lgkmcnt(0)
    s_cmp_eq_u32 s58, 0
    s_cbranch_scc1 L_rareN
L_backN:
    v_mov_b32 v28, s58
    v_mfma_f32_32x32x16_bf16 v[96:111], v[164:167], v[168:171], v[96:111]
    ds_read_b64_tr_b16 v[148:149], v25 offset:49152
    ds_read_b64_tr_b16 v[150:151], v25 offset:50176
    s_add_u32 m0, s43, 136272
    s_nop 0
    buffer_load_dwordx4 v237, s[16:19], s42 offen nt lds
    v_mov_b32 v197, v28
    v_mfma_f32_32x32x16_bf16 v[112:127], v[164:167], v[172:175], v[112:127]
    buffer_store_dwordx2 v[196:197], v198, s[36:39], s84 offen sc1
    v_mfma_f32_32x32x16_bf16 v[64:79], v[128:131], v[136:139], v[64:79]
    ds_read_b64_tr_b16 v[160:161], v24 offset:53248
    ds_read_b64_tr_b16 v[162:163], v24 offset:54272
    s_add_u32 m0, s43, 144592
    s_nop 0
    buffer_load_dwordx4 v237, s[20:23], s42 offen nt lds
    v_mfma_f32_16x16x32_bf16 a[244:247], v[128:131], a[240:243], a[244:247]
    v_mfma_f32_32x32x16_bf16 v[80:95], v[128:131], v[140:143], v[80:95]
    ds_read_b128 v[168:171], v17 offset:32768
    ds_read_b128 v[172:175], v17 offset:36864
    s_mov_b32 m0, 131072
    s_nop 0
    buffer_load_dwordx4 v239, s[60:63], s40 offen nt lds
    v_mfma_f32_32x32x16_bf16 v[96:111], v[132:135], v[136:139], v[96:111]
    ds_read_b64_tr_b16 v[164:165], v25 offset:53248
    ds_read_b64_tr_b16 v[166:167], v25 offset:54272
    v_mfma_f32_32x32x16_bf16 v[112:127], v[132:135], v[140:143], v[112:127]
    s_add_u32 m0, s92, 98304
    s_nop 0
    buffer_load_dwordx4 v4, s[8:11], s67 offen lds
    s_waitcnt lgkmcnt(6)
    v_mfma_f32_32x32x16_bf16 v[64:79], v[144:147], v[152:155], v[64:79]
    ds_read_b64_tr_b16 v[128:129], v24 offset:57344
    ds_read_b64_tr_b16 v[130:131], v24 offset:58368
    s_mov_b64 s[48:49], s[36:37]
    s_mov_b32 s87, 0
    s_mov_b32 s84, 0xfff98000
    v_mfma_f32_16x16x32_bf16 a[244:247], v[144:147], a[240:243], a[244:247]
    buffer_load_dwordx4 v5, s[8:11], s67 offen offset:1024 lds
    v_mfma_f32_32x32x16_bf16 v[80:95], v[144:147], v[156:159], v[80:95]
    ds_read_b128 v[136:139], v18 offset:32768
    ds_read_b128 v[140:143], v18 offset:36864
    v_mfma_f32_32x32x16_bf16 v[96:111], v[148:151], v[152:155], v[96:111]
    ds_read_b64_tr_b16 v[132:133], v25 offset:57344
    ds_read_b64_tr_b16 v[134:135], v25 offset:58368
    buffer_load_dwordx4 v6, s[8:11], s67 offen offset:2048 lds
    v_mfma_f32_32x32x16_bf16 v[112:127], v[148:151], v[156:159], v[112:127]
    s_waitcnt lgkmcnt(6)
    v_mfma_f32_32x32x16_bf16 v[64:79], v[160:163], v[168:171], v[64:79]
    ds_read_b64_tr_b16 v[144:145], v24 offset:61440
    ds_read_b64_tr_b16 v[146:147], v24 offset:62464
    ds_read_b128 v[152:155], v19 offset:32768
    buffer_load_dwordx4 v7, s[8:11], s67 offen offset:3072 lds
    v_mfma_f32_16x16x32_bf16 a[244:247], v[160:163], a[240:243], a[244:247]
    v_mfma_f32_32x32x16_bf16 v[80:95], v[160:163], v[172:175], v[80:95]
    ds_read_b128 v[156:159], v19 offset:36864
    ds_read_b64_tr_b16 v[148:149], v25 offset:61440
    ds_read_b64_tr_b16 v[150:151], v25 offset:62464
    s_add_u32 m0, s93, 98304
    s_nop 0
    buffer_load_dwordx4 v8, s[24:27], s75 offen lds
    v_mfma_f32_32x32x16_bf16 v[96:111], v[164:167], v[168:171], v[96:111]
    buffer_load_dwordx4 v9, s[24:27], s75 offen offset:1024 lds
    buffer_load_dwordx4 v10, s[24:27], s75 offen offset:2048 lds
    buffer_load_dwordx4 v11, s[24:27], s75 offen offset:3072 lds
    s_waitcnt vmcnt(14)
    s_waitcnt lgkmcnt(0)
    v_mfma_f32_32x32x16_bf16 v[112:127], v[164:167], v[172:175], v[112:127]
    s_barrier
    s_add_u32 m0, s92, 0
    s_nop 0
    buffer_load_dwordx4 v4, s[8:11], s68 offen lds
    s_lshl_b32 s21, s97, 1
    v_mfma_f32_32x32x16_bf16 v[64:79], v[128:131], v[136:139], v[64:79]
    ds_read_b64_tr_b16 v[160:161], v26 offset:16384
    ds_read_b64_tr_b16 v[162:163], v26 offset:17408
    s_add_u32 s21, s21, s86
    s_lshl_b32 s21, s21, 5
    s_lshl_b32 s6, s98, 1
    v_mfma_f32_16x16x32_bf16 a[244:247], v[128:131], a[240:243], a[244:247]
    buffer_load_dwordx4 v5, s[8:11], s68 offen offset:1024 lds
    v_mfma_f32_32x32x16_bf16 v[80:95], v[128:131], v[140:143], v[80:95]
    ds_read_b128 v[168:171], v20 offset:0
    ds_read_b128 v[172:175], v20 offset:4096
    s_add_u32 s6, s6, s85
    s_mul_i32 s7, s6, 37
    s_lshr_b32 s7, s7, 8
    v_mfma_f32_32x32x16_bf16 v[96:111], v[132:135], v[136:139], v[96:111]
    ds_read_b64_tr_b16 v[164:165], v27 offset:16384
    ds_read_b64_tr_b16 v[166:167], v27 offset:17408
    buffer_load_dwordx4 v6, s[8:11], s68 offen offset:2048 lds
    s_lshr_b32 s21, s21, 3
    s_add_u32 s21, s21, s7
    v_mfma_f32_32x32x16_bf16 v[112:127], v[132:135], v[140:143], v[112:127]
    s_lshl_b32 s21, s21, 7
    s_mul_i32 s7, s7, 7
    s_sub_u32 s6, s6, s7
    s_lshl_b32 s6, s6, 2
    s_add_u32 s21, s21, s6
    v_mfma_f32_32x32x16_bf16 v[64:79], v[144:147], v[152:155], v[64:79]
    ds_read_b64_tr_b16 v[128:129], v26 offset:20480
    ds_read_b64_tr_b16 v[130:131], v26 offset:21504
    buffer_load_dwordx4 v7, s[8:11], s68 offen offset:3072 lds
    s_add_u32 s21, s21, 11730944
    s_lshl_b32 s6, s100, 2
    v_mfma_f32_16x16x32_bf16 a[244:247], v[144:147], a[240:243], a[244:247]
    s_add_u32 s6, s6, s5
    v_mfma_f32_32x32x16_bf16 v[80:95], v[144:147], v[156:159], v[80:95]
    ds_read_b128 v[136:139], v21 offset:0
    ds_read_b128 v[140:143], v21 offset:4096
    s_add_u32 m0, s93, 0
    s_nop 0
    buffer_load_dwordx4 v8, s[24:27], s76 offen lds
    s_lshl_b32 s16, s6, 16
    v_mfma_f32_32x32x16_bf16 v[96:111], v[148:151], v[152:155], v[96:111]
    ds_read_b64_tr_b16 v[132:133], v27 offset:20480
    ds_read_b64_tr_b16 v[134:135], v27 offset:21504
    s_lshl_b32 s7, s99, 7
    s_sub_u32 s16, s16, s7
    s_add_u32 s16, s16, 7344000
    v_mfma_f32_32x32x16_bf16 v[112:127], v[148:151], v[156:159], v[112:127]
    buffer_load_dwordx4 v9, s[24:27], s76 offen offset:1024 lds
    s_add_u32 s17, s16, 4096
    s_lshl_b32 s18, s6, 1
    s_lshr_b32 s7, s99, 4
    s_add_u32 s18, s18, s7
    s_waitcnt lgkmcnt(6)
    v_mfma_f32_32x32x16_bf16 v[64:79], v[160:163], v[168:171], v[64:79]
    ds_read_b64_tr_b16 v[144:145], v26 offset:24576
    ds_read_b64_tr_b16 v[146:147], v26 offset:25600
    s_lshl_b32 s18, s18, 7
    s_and_b32 s7, s99, 15
    s_lshl_b32 s7, s7, 2
    v_mfma_f32_16x16x32_bf16 a[244:247], v[160:163], a[240:243], a[244:247]
    buffer_load_dwordx4 v10, s[24:27], s76 offen offset:2048 lds
    v_mfma_f32_32x32x16_bf16 v[80:95], v[160:163], v[172:175], v[80:95]
    ds_read_b128 v[152:155], v22 offset:0
    ds_read_b128 v[156:159], v22 offset:4096
    s_add_u32 s18, s18, s7
    s_add_u32 s18, s18, 11599872
    s_lshr_b32 s19, s101, 4
    v_mfma_f32_32x32x16_bf16 v[96:111], v[164:167], v[168:171], v[96:111]
    ds_read_b64_tr_b16 v[148:149], v27 offset:24576
    ds_read_b64_tr_b16 v[150:151], v27 offset:25600
    buffer_load_dwordx4 v11, s[24:27], s76 offen offset:3072 lds
    s_lshl_b32 s19, s19, 8
    s_lshl_b32 s6, s85, 7
    v_mfma_f32_32x32x16_bf16 v[112:127], v[164:167], v[172:175], v[112:127]
    s_sub_u32 s19, s19, s6
    s_add_u32 s19, s19, 11600000
    s_lshl_b32 s6, s85, 11
    s_lshl_b32 s62, s101, 12
    s_add_u32 s20, s62, s6
    s_waitcnt lgkmcnt(6)
    v_mfma_f32_32x32x16_bf16 v[64:79], v[128:131], v[136:139], v[64:79]
    ds_read_b64_tr_b16 v[160:161], v26 offset:28672
    ds_read_b64_tr_b16 v[162:163], v26 offset:29696
    ds_read_b128 v[168:171], v23 offset:0
    s_add_u32 s23, s20, 9437184
    s_add_u32 s20, s20, 7340032
    v_mfma_f32_16x16x32_bf16 a[244:247], v[128:131], a[240:243], a[244:247]
    s_lshl_b32 s6, s85, 1
    v_mfma_f32_32x32x16_bf16 v[80:95], v[128:131], v[140:143], v[80:95]
    ds_read_b128 v[172:175], v23 offset:4096
    ds_read_b64_tr_b16 v[164:165], v27 offset:28672
    ds_read_b64_tr_b16 v[166:167], v27 offset:29696
    s_add_u32 s62, s62, s6
    v_and_b32_e64 v252, 7, v1
    v_mfma_f32_32x32x16_bf16 v[96:111], v[132:135], v[136:139], v[96:111]
    v_mul_u32_u24 v253, 1040, v252
    v_lshrrev_b32_e64 v254, 3, v1
    v_lshl_add_u32 v253, v254, 2, v253
    s_lshl_b32 s6, s5, 5
    s_add_u32 s6, s6, 131072
    v_add_u32 v253, s6, v253
    v_add_u32 v255, 1040, v253
    v_xor_b32 v252, 7, v252
    v_lshlrev_b32 v252, 4, v252
    v_lshl_add_u32 v252, v254, 13, v252
    v_add_u32 v254, 9360, v253
    s_waitcnt vmcnt(8)
    s_waitcnt lgkmcnt(0)
    v_mfma_f32_32x32x16_bf16 v[112:127], v[132:135], v[140:143], v[112:127]
    s_barrier
    ds_read2_b32 v[232:233], v253 offset0:160 offset1:192
    ds_read_b32 v234, v253 offset:896
    ds_read2_b32 v[236:237], v255 offset0:0 offset1:32
    v_mfma_f32_32x32x16_bf16 v[64:79], v[144:147], v[152:155], v[64:79]
    ds_read_b64_tr_b16 v[128:129], v26 offset:49152
    ds_read_b64_tr_b16 v[130:131], v26 offset:50176
    ds_read2_b32 v[238:239], v255 offset0:64 offset1:96
    ds_read2_b32 v[240:241], v255 offset0:128 offset1:160
    ds_read2_b32 v[242:243], v255 offset0:192 offset1:224
    v_mfma_f32_16x16x32_bf16 a[244:247], v[144:147], a[240:243], a[244:247]
    ds_read2_b32 v[244:245], v254 offset0:0 offset1:32
    v_mfma_f32_32x32x16_bf16 v[80:95], v[144:147], v[156:159], v[80:95]
    ds_read_b128 v[136:139], v20 offset:32768
    ds_read_b128 v[140:143], v20 offset:36864
    ds_read2_b32 v[246:247], v254 offset0:64 offset1:96
    ds_read2_b32 v[248:249], v254 offset0:128 offset1:160
    ds_read2_b32 v[250:251], v254 offset0:192 offset1:224
    v_mfma_f32_32x32x16_bf16 v[96:111], v[148:151], v[152:155], v[96:111]
    ds_read_b64_tr_b16 v[132:133], v27 offset:49152
    ds_read_b64_tr_b16 v[134:135], v27 offset:50176
    v_mfma_f32_32x32x16_bf16 v[112:127], v[148:151], v[156:159], v[112:127]
    v_lshlrev_b32 v220, 16, v228
    v_lshlrev_b32_e64 v221, 16, v230
    v_and_b32 v222, 0xffff0000, v228
    v_and_b32 v223, 0xffff0000, v230
    v_lshlrev_b32 v224, 16, v229
    v_lshlrev_b32 v225, 16, v231
    v_and_b32 v226, 0xffff0000, v229
    v_and_b32 v227, 0xffff0000, v231
    s_add_u32 m0, s92, 32768
    s_nop 0
    buffer_load_dwordx4 v4, s[8:11], s69 offen lds
    s_waitcnt lgkmcnt(15)
    v_lshlrev_b32_e64 v176, 16, v232
    v_and_b32 v177, 0xffff0000, v232
    v_lshlrev_b32_e64 v178, 16, v233
    v_and_b32 v179, 0xffff0000, v233
    s_waitcnt lgkmcnt(14)
    v_lshlrev_b32 v180, 16, v234
    v_and_b32 v181, 0xffff0000, v234
    s_waitcnt lgkmcnt(13)
    v_lshlrev_b32 v184, 16, v236
    v_and_b32 v185, 0xffff0000, v236
    buffer_load_dwordx4 v5, s[8:11], s69 offen offset:1024 lds
    v_lshlrev_b32_e64 v186, 16, v237
    v_and_b32 v187, 0xffff0000, v237
    s_waitcnt lgkmcnt(10)
    v_lshlrev_b32 v188, 16, v238
    v_and_b32 v189, 0xffff0000, v238
    v_lshlrev_b32_e64 v190, 16, v239
    v_and_b32 v191, 0xffff0000, v239
    s_waitcnt lgkmcnt(9)
    v_lshlrev_b32 v192, 16, v240
    v_and_b32 v193, 0xffff0000, v240
    buffer_load_dwordx4 v6, s[8:11], s69 offen offset:2048 lds
    v_lshlrev_b32_e64 v194, 16, v241
    v_and_b32 v195, 0xffff0000, v241
    s_waitcnt lgkmcnt(8)
    v_lshlrev_b32 v196, 16, v242
    v_and_b32 v197, 0xffff0000, v242
    v_lshlrev_b32_e64 v198, 16, v243
    v_and_b32 v199, 0xffff0000, v243
    v_pk_mul_f32 v[200:201], v[184:185], v[220:221]
    v_pk_mul_f32 v[202:203], v[186:187], v[220:221]
    buffer_load_dwordx4 v7, s[8:11], s69 offen offset:3072 lds
    v_pk_mul_f32 v[204:205], v[188:189], v[220:221]
    v_pk_mul_f32 v[206:207], v[190:191], v[220:221]
    v_pk_mul_f32 v[208:209], v[192:193], v[220:221]
    v_pk_mul_f32 v[210:211], v[194:195], v[220:221]
    v_pk_mul_f32 v[212:213], v[196:197], v[220:221]
    v_pk_mul_f32 v[214:215], v[198:199], v[220:221]
    v_pk_fma_f32 v[200:201], v[180:181], v[222:223], v[200:201]
    v_pk_fma_f32 v[202:203], v[184:185], v[222:223], v[202:203]
    s_add_u32 m0, s93, 32768
    s_nop 0
    buffer_load_dwordx4 v8, s[24:27], s77 offen lds
    v_pk_fma_f32 v[204:205], v[186:187], v[222:223], v[204:205]
    v_pk_fma_f32 v[206:207], v[188:189], v[222:223], v[206:207]
    v_pk_fma_f32 v[208:209], v[190:191], v[222:223], v[208:209]
    v_pk_fma_f32 v[210:211], v[192:193], v[222:223], v[210:211]
    v_pk_fma_f32 v[212:213], v[194:195], v[222:223], v[212:213]
    v_pk_fma_f32 v[214:215], v[196:197], v[222:223], v[214:215]
    v_pk_fma_f32 v[200:201], v[178:179], v[224:225], v[200:201]
    v_pk_fma_f32 v[202:203], v[180:181], v[224:225], v[202:203]
    buffer_load_dwordx4 v9, s[24:27], s77 offen offset:1024 lds
    v_pk_fma_f32 v[204:205], v[184:185], v[224:225], v[204:205]
    v_pk_fma_f32 v[206:207], v[186:187], v[224:225], v[206:207]
    v_pk_fma_f32 v[208:209], v[188:189], v[224:225], v[208:209]
    v_pk_fma_f32 v[210:211], v[190:191], v[224:225], v[210:211]
    v_pk_fma_f32 v[212:213], v[192:193], v[224:225], v[212:213]
    v_pk_fma_f32 v[214:215], v[194:195], v[224:225], v[214:215]
    v_pk_fma_f32 v[200:201], v[176:177], v[226:227], v[200:201]
    v_pk_fma_f32 v[202:203], v[178:179], v[226:227], v[202:203]
    buffer_load_dwordx4 v10, s[24:27], s77 offen offset:2048 lds
    v_pk_fma_f32 v[204:205], v[180:181], v[226:227], v[204:205]
    v_pk_fma_f32 v[206:207], v[184:185], v[226:227], v[206:207]
    v_pk_fma_f32 v[208:209], v[186:187], v[226:227], v[208:209]
    v_pk_fma_f32 v[210:211], v[188:189], v[226:227], v[210:211]
    v_pk_fma_f32 v[212:213], v[190:191], v[226:227], v[212:213]
    v_pk_fma_f32 v[214:215], v[192:193], v[226:227], v[214:215]
    s_waitcnt lgkmcnt(7)
    v_lshlrev_b32_e64 v176, 16, v244
    v_and_b32 v177, 0xffff0000, v244
    buffer_load_dwordx4 v11, s[24:27], s77 offen offset:3072 lds
    v_lshlrev_b32_e64 v178, 16, v245
    v_and_b32 v179, 0xffff0000, v245
    s_waitcnt lgkmcnt(4)
    v_lshlrev_b32 v180, 16, v246
    v_and_b32 v181, 0xffff0000, v246
    v_lshlrev_b32_e64 v182, 16, v247
    v_and_b32 v183, 0xffff0000, v247
    s_waitcnt lgkmcnt(3)
    v_lshlrev_b32 v184, 16, v248
    v_and_b32 v185, 0xffff0000, v248
    v_lshlrev_b32_e64 v186, 16, v249
    v_and_b32 v187, 0xffff0000, v249
    s_waitcnt lgkmcnt(2)
    v_lshlrev_b32 v188, 16, v250
    v_and_b32 v189, 0xffff0000, v250
    v_lshlrev_b32_e64 v190, 16, v251
    v_and_b32 v191, 0xffff0000, v251
    v_pk_mul_f32 v[200:201], v[200:201], v[176:177]
    v_pk_mul_f32 v[202:203], v[202:203], v[178:179]
    v_pk_mul_f32 v[204:205], v[204:205], v[180:181]
    v_pk_mul_f32 v[206:207], v[206:207], v[182:183]
    v_pk_mul_f32 v[208:209], v[208:209], v[184:185]
    v_pk_mul_f32 v[210:211], v[210:211], v[186:187]
    v_pk_mul_f32 v[212:213], v[212:213], v[188:189]
    v_pk_mul_f32 v[214:215], v[214:215], v[190:191]
    v_cvt_pk_bf16_f32 v232, v214, v212
    v_cvt_pk_bf16_f32 v233, v210, v208
    v_cvt_pk_bf16_f32 v234, v206, v204
    v_cvt_pk_bf16_f32 v235, v202, v200
    buffer_store_dwordx4 v[232:235], v252, s[36:39], s16 offen sc1
    v_cvt_pk_bf16_f32 v236, v215, v213
    v_cvt_pk_bf16_f32 v237, v211, v209
    v_cvt_pk_bf16_f32 v238, v207, v205
    v_cvt_pk_bf16_f32 v239, v203, v201
    buffer_store_dwordx4 v[236:239], v252, s[36:39], s17 offen sc1
    v_mfma_f32_32x32x16_bf16 v[64:79], v[160:163], v[168:171], v[64:79]
    ds_read_b64_tr_b16 v[144:145], v26 offset:53248
    ds_read_b64_tr_b16 v[146:147], v26 offset:54272
    s_add_u32 m0, s92, 65536
    s_nop 0
    buffer_load_dwordx4 v4, s[8:11], s70 offen lds
    v_mfma_f32_16x16x32_bf16 a[244:247], v[160:163], a[240:243], a[244:247]
    v_mfma_f32_32x32x16_bf16 v[80:95], v[160:163], v[172:175], v[80:95]
    ds_read_b128 v[152:155], v21 offset:32768
    ds_read_b128 v[156:159], v21 offset:36864
    buffer_load_dwordx4 v5, s[8:11], s70 offen offset:1024 lds
    v_mfma_f32_32x32x16_bf16 v[96:111], v[164:167], v[168:171], v[96:111]
    ds_read_b64_tr_b16 v[148:149], v27 offset:53248
    ds_read_b64_tr_b16 v[150:151], v27 offset:54272
    v_mfma_f32_32x32x16_bf16 v[112:127], v[164:167], v[172:175], v[112:127]
    buffer_load_dwordx4 v6, s[8:11], s70 offen offset:2048 lds
    s_waitcnt lgkmcnt(6)
    v_mfma_f32_32x32x16_bf16 v[64:79], v[128:131], v[136:139], v[64:79]
    ds_read_b64_tr_b16 v[160:161], v26 offset:57344
    ds_read_b64_tr_b16 v[162:163], v26 offset:58368
    s_lshl_b32 s22, s99, 2
    v_mfma_f32_16x16x32_bf16 a[244:247], v[128:131], a[240:243], a[244:247]
    buffer_load_dwordx4 v7, s[8:11], s70 offen offset:3072 lds
    v_mfma_f32_32x32x16_bf16 v[80:95], v[128:131], v[140:143], v[80:95]
    ds_read_b128 v[168:171], v22 offset:32768
    ds_read_b128 v[172:175], v22 offset:36864
    s_mul_i32 s42, s5, 1
    s_add_u32 s22, s22, s42
    v_mfma_f32_32x32x16_bf16 v[96:111], v[132:135], v[136:139], v[96:111]
    ds_read_b64_tr_b16 v[164:165], v27 offset:57344
    ds_read_b64_tr_b16 v[166:167], v27 offset:58368
    s_add_u32 m0, s93, 65536
    s_nop 0
    buffer_load_dwordx4 v8, s[24:27], s78 offen lds
    v_mfma_f32_32x32x16_bf16 v[112:127], v[132:135], v[140:143], v[112:127]
    s_lshl_b32 s22, s22, 7
    s_add_u32 s22, s22, 11730944
    s_lshr_b32 s52, s101, 5
    s_waitcnt lgkmcnt(6)
    v_mfma_f32_32x32x16_bf16 v[64:79], v[144:147], v[152:155], v[64:79]
    ds_read_b64_tr_b16 v[128:129], v26 offset:61440
    ds_read_b64_tr_b16 v[130:131], v26 offset:62464
    ds_read_b128 v[136:139], v23 offset:32768
    buffer_load_dwordx4 v9, s[24:27], s78 offen offset:1024 lds
    v_mfma_f32_16x16x32_bf16 a[244:247], v[144:147], a[240:243], a[244:247]
    s_lshl_b32 s52, s52, 1
    v_mfma_f32_32x32x16_bf16 v[80:95], v[144:147], v[156:159], v[80:95]
    ds_read_b128 v[140:143], v23 offset:36864
    ds_read_b64_tr_b16 v[132:133], v27 offset:61440
    ds_read_b64_tr_b16 v[134:135], v27 offset:62464
    buffer_load_dwordx4 v10, s[24:27], s78 offen offset:2048 lds
    v_mfma_f32_32x32x16_bf16 v[96:111], v[148:151], v[152:155], v[96:111]
    s_add_u32 s52, s52, s85
    s_lshl_b32 s52, s52, 7
    s_waitcnt vmcnt(17)
    s_waitcnt lgkmcnt(0)
    v_mfma_f32_32x32x16_bf16 v[112:127], v[148:151], v[156:159], v[112:127]
    s_barrier
    buffer_load_dwordx4 v11, s[24:27], s78 offen offset:3072 lds
    s_and_b32 s42, s101, 31
    v_mfma_f32_32x32x16_bf16 v[64:79], v[160:163], v[168:171], v[64:79]
    ds_read_b64_tr_b16 v[144:145], v24 offset:16384
    ds_read_b64_tr_b16 v[146:147], v24 offset:17408
    s_lshl_b32 s42, s42, 2
    s_add_u32 s52, s52, s42
    v_mfma_f32_16x16x32_bf16 a[244:247], v[160:163], a[240:243], a[244:247]
    s_add_u32 m0, s92, 98304
    s_nop 0
    buffer_load_dwordx4 v4, s[8:11], s71 offen lds
    v_mfma_f32_32x32x16_bf16 v[80:95], v[160:163], v[172:175], v[80:95]
    ds_read_b128 v[152:155], v16 offset:0
    ds_read_b128 v[156:159], v16 offset:4096
    s_add_u32 s52, s52, 11862016
    v_mfma_f32_32x32x16_bf16 v[96:111], v[164:167], v[168:171], v[96:111]
    ds_read_b64_tr_b16 v[148:149], v25 offset:16384
    ds_read_b64_tr_b16 v[150:151], v25 offset:17408
    buffer_load_dwordx4 v5, s[8:11], s71 offen offset:1024 lds
    s_lshl_b32 s42, s100, 1
    v_mfma_f32_32x32x16_bf16 v[112:127], v[164:167], v[172:175], v[112:127]
    s_add_u32 s42, s42, s85
    s_lshl_b32 s53, s42, 8
    v_mfma_f32_32x32x16_bf16 v[64:79], v[128:131], v[136:139], v[64:79]
    ds_read_b64_tr_b16 v[160:161], v24 offset:20480
    ds_read_b64_tr_b16 v[162:163], v24 offset:21504
    buffer_load_dwordx4 v6, s[8:11], s71 offen offset:2048 lds
    s_lshr_b32 s43, s99, 4
    v_mfma_f32_16x16x32_bf16 a[244:247], v[128:131], a[240:243], a[244:247]
    v_mfma_f32_32x32x16_bf16 v[80:95], v[128:131], v[140:143], v[80:95]
    ds_read_b128 v[168:171], v17 offset:0
    ds_read_b128 v[172:175], v17 offset:4096
    buffer_load_dwordx4 v7, s[8:11], s71 offen offset:3072 lds
    s_lshl_b32 s43, s43, 7
    v_mfma_f32_32x32x16_bf16 v[96:111], v[132:135], v[136:139], v[96:111]
    ds_read_b64_tr_b16 v[164:165], v25 offset:20480
    ds_read_b64_tr_b16 v[166:167], v25 offset:21504
    s_add_u32 s53, s53, s43
    s_add_u32 s53, s53, 11862016
    v_mfma_f32_32x32x16_bf16 v[112:127], v[132:135], v[140:143], v[112:127]
    s_add_u32 m0, s93, 98304
    s_nop 0
    buffer_load_dwordx4 v8, s[24:27], s79 offen lds
    s_lshl_b32 s55, s42, 17
    s_waitcnt lgkmcnt(6)
    v_mfma_f32_32x32x16_bf16 v[64:79], v[144:147], v[152:155], v[64:79]
    ds_read_b64_tr_b16 v[128:129], v24 offset:24576
    ds_read_b64_tr_b16 v[130:131], v24 offset:25600
    s_lshl_b32 s60, s42, 6
    s_lshl_b32 s42, s99, 1
    v_mfma_f32_16x16x32_bf16 a[244:247], v[144:147], a[240:243], a[244:247]
    buffer_load_dwordx4 v9, s[24:27], s79 offen offset:1024 lds
    v_mfma_f32_32x32x16_bf16 v[80:95], v[144:147], v[156:159], v[80:95]
    ds_read_b128 v[136:139], v18 offset:0
    ds_read_b128 v[140:143], v18 offset:4096
    s_nop 0
    s_getreg_b32 s50, hwreg(HW_REG_IB_STS)
    s_and_b32 s50, s50, 0xc0000f
    s_or_b32 s50, s50, s87
    s_cmp_le_u32 s50, 0xe
    s_cselect_b32 s50, 12582912, 0
    s_cselect_b32 s87, 0x80000000, s87
    buffer_store_dword v28, v3, s[48:51], s18 offen sc1
    v_mfma_f32_32x32x16_bf16 v[96:111], v[148:151], v[152:155], v[96:111]
    ds_read_b64_tr_b16 v[132:133], v25 offset:24576
    ds_read_b64_tr_b16 v[134:135], v25 offset:25600
    buffer_load_dwordx4 v10, s[24:27], s79 offen offset:2048 lds
    v_mfma_f32_32x32x16_bf16 v[112:127], v[148:151], v[156:159], v[112:127]
    s_add_u32 s42, s42, s86
    s_waitcnt lgkmcnt(6)
    v_mfma_f32_32x32x16_bf16 v[64:79], v[160:163], v[168:171], v[64:79]
    ds_read_b64_tr_b16 v[144:145], v24 offset:28672
    ds_read_b64_tr_b16 v[146:147], v24 offset:29696
    ds_read_b128 v[152:155], v19 offset:0
    buffer_load_dwordx4 v11, s[24:27], s79 offen offset:3072 lds
    s_lshl_b32 s43, s42, 6
    v_mfma_f32_16x16x32_bf16 a[244:247], v[160:163], a[240:243], a[244:247]
    v_mfma_f32_32x32x16_bf16 v[80:95], v[160:163], v[172:175], v[80:95]
    ds_read_b128 v[156:159], v19 offset:4096
    ds_read_b64_tr_b16 v[148:149], v25 offset:28672
    ds_read_b64_tr_b16 v[150:151], v25 offset:29696
    buffer_load_dwordx2 v[212:213], v29, s[36:39], s82 offen offset:0 sc1
    s_add_u32 s55, s55, s43
    v_mfma_f32_32x32x16_bf16 v[96:111], v[164:167], v[168:171], v[96:111]
    s_add_u32 s55, s55, 9437184
    s_lshl_b32 s43, s42, 15
    s_waitcnt vmcnt(20)
    s_waitcnt lgkmcnt(0)
    v_mfma_f32_32x32x16_bf16 v[112:127], v[164:167], v[172:175], v[112:127]
    s_barrier
    buffer_load_dwordx2 v[214:215], v29, s[36:39], s82 offen offset:512 sc1
    s_sub_u32 s62, s23, 0x900000
    s_add_u32 s60, s60, s43
    v_mfma_f32_32x32x16_bf16 v[64:79], v[128:131], v[136:139], v[64:79]
    ds_read_b64_tr_b16 v[160:161], v24 offset:49152
    ds_read_b64_tr_b16 v[162:163], v24 offset:50176
    s_lshl_b32 s61, s42, 9
    v_accvgpr_read_b32 v230, a248
    v_mfma_f32_16x16x32_bf16 a[244:247], v[128:131], a[240:243], a[244:247]
    s_add_u32 s61, s61, 11534336
    v_mfma_f32_32x32x16_bf16 v[80:95], v[128:131], v[140:143], v[80:95]
    ds_read_b128 v[168:171], v16 offset:32768
    ds_read_b128 v[172:175], v16 offset:36864
    s_getreg_b32 s50, hwreg(HW_REG_IB_STS)
    s_and_b32 s50, s50, 0xc0000f
    s_or_b32 s50, s50, s87
    s_cmp_le_u32 s50, 0x400003
    s_cselect_b32 s50, 12582912, 0
    s_cselect_b32 s87, 0x80000000, s87
    buffer_store_dword v28, v3, s[48:51], s18 offen sc1
    v_mfma_f32_32x32x16_bf16 v[96:111], v[132:135], v[136:139], v[96:111]
    ds_read_b64_tr_b16 v[164:165], v25 offset:49152
    ds_read_b64_tr_b16 v[166:167], v25 offset:50176
    v_mfma_f32_32x32x16_bf16 v[112:127], v[132:135], v[140:143], v[112:127]
    buffer_load_dwordx4 v[232:235], v2, s[32:35], s62 offen nt
    s_mul_i32 s63, s42, 114688
    v_accvgpr_read_b32 v231, a249
    s_lshl_b32 s7, s86, 4
    v_mfma_f32_32x32x16_bf16 v[64:79], v[144:147], v[152:155], v[64:79]
    ds_read_b64_tr_b16 v[128:129], v24 offset:53248
    ds_read_b64_tr_b16 v[130:131], v24 offset:54272
    s_xor_b32 s42, s42, 1
    s_mul_i32 s54, s42, 114688
    v_mfma_f32_16x16x32_bf16 a[244:247], v[144:147], a[240:243], a[244:247]
    v_lshrrev_b32_e64 v230, s7, v230
    v_mfma_f32_32x32x16_bf16 v[80:95], v[144:147], v[156:159], v[80:95]
    ds_read_b128 v[136:139], v17 offset:32768
    ds_read_b128 v[140:143], v17 offset:36864
    s_mul_i32 s42, s5, 28672
    s_lshl_b32 s43, s83, 12
    v_mfma_f32_32x32x16_bf16 v[96:111], v[148:151], v[152:155], v[96:111]
    ds_read_b64_tr_b16 v[132:133], v25 offset:53248
    ds_read_b64_tr_b16 v[134:135], v25 offset:54272
    s_add_u32 s42, s42, s43
    v_lshlrev_b32_e64 v230, 16, v230
    v_mfma_f32_32x32x16_bf16 v[112:127], v[148:151], v[156:159], v[112:127]
    buffer_load_dword v240, v2, s[32:35], s62 offen offset:16
    s_add_u32 s54, s54, s42
    s_add_u32 s63, s63, s42
    v_lshlrev_b32 v231, 16, v231
    s_waitcnt lgkmcnt(6)
    v_mfma_f32_32x32x16_bf16 v[64:79], v[160:163], v[168:171], v[64:79]
    ds_read_b64_tr_b16 v[144:145], v24 offset:57344
    ds_read_b64_tr_b16 v[146:147], v24 offset:58368
    v_mul_lo_u32 v231, v231, s85
    v_readfirstlane_b32 s59, v230
    v_mfma_f32_16x16x32_bf16 a[244:247], v[160:163], a[240:243], a[244:247]
    s_mul_i32 s7, s5, 4160
    v_mfma_f32_32x32x16_bf16 v[80:95], v[160:163], v[172:175], v[80:95]
    ds_read_b128 v[152:155], v18 offset:32768
    ds_read_b128 v[156:159], v18 offset:36864
    s_getreg_b32 s50, hwreg(HW_REG_IB_STS)
    s_and_b32 s50, s50, 0xc0000f
    s_or_b32 s50, s50, s87
    s_cmp_le_u32 s50, 0x400006
    s_cselect_b32 s50, 12582912, 0
    s_cselect_b32 s87, 0x80000000, s87
    buffer_store_dword v28, v3, s[48:51], s18 offen sc1
    v_mfma_f32_32x32x16_bf16 v[96:111], v[164:167], v[168:171], v[96:111]
    ds_read_b64_tr_b16 v[148:149], v25 offset:57344
    ds_read_b64_tr_b16 v[150:151], v25 offset:58368
    v_mfma_f32_32x32x16_bf16 v[112:127], v[164:167], v[172:175], v[112:127]
    buffer_load_dwordx4 v[236:239], v2, s[32:35], s62 offen offset:1024 nt
    v_and_b32 v230, 7, v1
    s_waitcnt lgkmcnt(6)
    v_mfma_f32_32x32x16_bf16 v[64:79], v[128:131], v[136:139], v[64:79]
    ds_read_b64_tr_b16 v[160:161], v24 offset:61440
    ds_read_b64_tr_b16 v[162:163], v24 offset:62464
    ds_read_b128 v[168:171], v19 offset:32768
    v_mfma_f32_16x16x32_bf16 a[244:247], v[128:131], a[240:243], a[244:247]
    v_mfma_f32_32x32x16_bf16 v[80:95], v[128:131], v[140:143], v[80:95]
    ds_read_b128 v[172:175], v19 offset:36864
    ds_read_b64_tr_b16 v[164:165], v25 offset:61440
    ds_read_b64_tr_b16 v[166:167], v25 offset:62464
    v_mfma_f32_32x32x16_bf16 v[96:111], v[132:135], v[136:139], v[96:111]
    v_cmp_eq_u32 vcc, 7, v230
    v_lshlrev_b32_e64 v230, 2, v230
    s_add_u32 s7, s7, 131072
    v_cndmask_b32 v231, 0, v231, vcc
    v_add_u32 v230, s7, v230
    ds_write_b32 v230, v231
    s_waitcnt vmcnt(16)
    s_waitcnt lgkmcnt(0)
    v_mfma_f32_32x32x16_bf16 v[112:127], v[132:135], v[140:143], v[112:127]
    s_barrier
    buffer_load_dword v241, v2, s[32:35], s62 offen offset:1040
    v_mfma_f32_32x32x16_bf16 v[64:79], v[144:147], v[152:155], v[64:79]
    ds_read_b64_tr_b16 v[128:129], v26 offset:16384
    ds_read_b64_tr_b16 v[130:131], v26 offset:17408
    s_cmp_eq_u32 s87, 0
    s_cselect_b32 s50, 12582912, 0
    s_mov_b32 s87, 0
    buffer_store_dword v28, v3, s[48:51], s18 offen sc1
    v_mfma_f32_16x16x32_bf16 a[244:247], v[144:147], a[240:243], a[244:247]
    v_mfma_f32_32x32x16_bf16 v[80:95], v[144:147], v[156:159], v[80:95]
    ds_read_b128 v[136:139], v20 offset:0
    ds_read_b128 v[140:143], v20 offset:4096
    v_mfma_f32_32x32x16_bf16 v[96:111], v[148:151], v[152:155], v[96:111]
    ds_read_b64_tr_b16 v[132:133], v27 offset:16384
    ds_read_b64_tr_b16 v[134:135], v27 offset:17408
    v_mfma_f32_32x32x16_bf16 v[112:127], v[148:151], v[156:159], v[112:127]
    s_add_u32 m0, s80, 0
    s_nop 0
    buffer_load_dwordx4 v12, s[28:31], s81 offen lds
    v_mfma_f32_32x32x16_bf16 v[64:79], v[160:163], v[168:171], v[64:79]
    ds_read_b64_tr_b16 v[144:145], v26 offset:20480
    ds_read_b64_tr_b16 v[146:147], v26 offset:21504
    v_mfma_f32_16x16x32_bf16 a[244:247], v[160:163], a[240:243], a[244:247]
    v_mfma_f32_32x32x16_bf16 v[80:95], v[160:163], v[172:175], v[80:95]
    ds_read_b128 v[152:155], v21 offset:0
    ds_read_b128 v[156:159], v21 offset:4096
    v_mfma_f32_32x32x16_bf16 v[96:111], v[164:167], v[168:171], v[96:111]
    ds_read_b64_tr_b16 v[148:149], v27 offset:20480
    ds_read_b64_tr_b16 v[150:151], v27 offset:21504
    v_mfma_f32_32x32x16_bf16 v[112:127], v[164:167], v[172:175], v[112:127]
    buffer_load_dwordx4 v13, s[28:31], s81 offen offset:1024 lds
    s_waitcnt lgkmcnt(6)
    v_mfma_f32_32x32x16_bf16 v[64:79], v[128:131], v[136:139], v[64:79]
    ds_read_b64_tr_b16 v[160:161], v26 offset:24576
    ds_read_b64_tr_b16 v[162:163], v26 offset:25600
    v_mfma_f32_16x16x32_bf16 a[244:247], v[128:131], a[240:243], a[244:247]
    v_mfma_f32_32x32x16_bf16 v[80:95], v[128:131], v[140:143], v[80:95]
    ds_read_b128 v[168:171], v22 offset:0
    ds_read_b128 v[172:175], v22 offset:4096
    v_mfma_f32_32x32x16_bf16 v[96:111], v[132:135], v[136:139], v[96:111]
    ds_read_b64_tr_b16 v[164:165], v27 offset:24576
    ds_read_b64_tr_b16 v[166:167], v27 offset:25600
    v_mfma_f32_32x32x16_bf16 v[112:127], v[132:135], v[140:143], v[112:127]
    buffer_load_dwordx4 v14, s[28:31], s81 offen offset:2048 lds
    s_waitcnt lgkmcnt(6)
    v_mfma_f32_32x32x16_bf16 v[64:79], v[144:147], v[152:155], v[64:79]
    ds_read_b64_tr_b16 v[128:129], v26 offset:28672
    ds_read_b64_tr_b16 v[130:131], v26 offset:29696
    ds_read_b128 v[136:139], v23 offset:0
    v_mfma_f32_16x16x32_bf16 a[244:247], v[144:147], a[240:243], a[244:247]
    v_mfma_f32_32x32x16_bf16 v[80:95], v[144:147], v[156:159], v[80:95]
    ds_read_b128 v[140:143], v23 offset:4096
    ds_read_b64_tr_b16 v[132:133], v27 offset:28672
    ds_read_b64_tr_b16 v[134:135], v27 offset:29696
    v_mfma_f32_32x32x16_bf16 v[96:111], v[148:151], v[152:155], v[96:111]
    s_waitcnt vmcnt(12)
    s_waitcnt lgkmcnt(0)
    v_mfma_f32_32x32x16_bf16 v[112:127], v[148:151], v[156:159], v[112:127]
    s_barrier
    buffer_load_dwordx4 v15, s[28:31], s81 offen offset:3072 lds
    s_mul_i32 s7, s86, 8320
    v_mfma_f32_32x32x16_bf16 v[64:79], v[160:163], v[168:171], v[64:79]
    ds_read_b64_tr_b16 v[144:145], v26 offset:49152
    ds_read_b64_tr_b16 v[146:147], v26 offset:50176
    s_lshl_b32 s6, s85, 11
    v_mfma_f32_16x16x32_bf16 a[244:247], v[160:163], a[240:243], a[244:247]
    v_mfma_f32_32x32x16_bf16 v[80:95], v[160:163], v[172:175], v[80:95]
    ds_read_b128 v[152:155], v20 offset:32768
    ds_read_b128 v[156:159], v20 offset:36864
    s_add_u32 s7, s7, s6
    v_mfma_f32_32x32x16_bf16 v[96:111], v[164:167], v[168:171], v[96:111]
    ds_read_b64_tr_b16 v[148:149], v27 offset:49152
    ds_read_b64_tr_b16 v[150:151], v27 offset:50176
    s_add_u32 s7, s7, 131104
    v_mfma_f32_32x32x16_bf16 v[112:127], v[164:167], v[172:175], v[112:127]
    s_add_u32 m0, s80, 4096
    s_add_u32 s81, s81, 32768
    buffer_load_dwordx4 v12, s[28:31], s81 offen lds
    v_add_u32_e64 v242, s7, v2
    v_mfma_f32_32x32x16_bf16 v[64:79], v[128:131], v[136:139], v[64:79]
    ds_read_b64_tr_b16 v[160:161], v26 offset:53248
    ds_read_b64_tr_b16 v[162:163], v26 offset:54272
    s_waitcnt vmcnt(10)
    ds_write_b128 v242, v[232:235] offset:0
    v_mfma_f32_16x16x32_bf16 a[244:247], v[128:131], a[240:243], a[244:247]
    v_alignbit_b32 v244, v233, v232, 16
    v_mfma_f32_32x32x16_bf16 v[80:95], v[128:131], v[140:143], v[80:95]
    ds_read_b128 v[168:171], v21 offset:32768
    ds_read_b128 v[172:175], v21 offset:36864
    v_alignbit_b32 v245, v234, v233, 16
    v_mfma_f32_32x32x16_bf16 v[96:111], v[132:135], v[136:139], v[96:111]
    ds_read_b64_tr_b16 v[164:165], v27 offset:53248
    ds_read_b64_tr_b16 v[166:167], v27 offset:54272
    v_alignbit_b32 v246, v235, v234, 16
    v_mfma_f32_32x32x16_bf16 v[112:127], v[132:135], v[140:143], v[112:127]
    buffer_load_dwordx4 v13, s[28:31], s81 offen offset:1024 lds
    s_waitcnt vmcnt(10)
    v_alignbit_b32 v247, v240, v235, 16
    s_waitcnt lgkmcnt(7)
    v_mfma_f32_32x32x16_bf16 v[64:79], v[144:147], v[152:155], v[64:79]
    ds_read_b64_tr_b16 v[128:129], v26 offset:57344
    ds_read_b64_tr_b16 v[130:131], v26 offset:58368
    ds_write_b128 v242, v[244:247] offset:4160
    v_mfma_f32_16x16x32_bf16 a[244:247], v[144:147], a[240:243], a[244:247]
    s_waitcnt vmcnt(8)
    ds_write_b128 v242, v[236:239] offset:1024
    v_mfma_f32_32x32x16_bf16 v[80:95], v[144:147], v[156:159], v[80:95]
    ds_read_b128 v[136:139], v22 offset:32768
    ds_read_b128 v[140:143], v22 offset:36864
    v_alignbit_b32 v248, v237, v236, 16
    v_mfma_f32_32x32x16_bf16 v[96:111], v[148:151], v[152:155], v[96:111]
    ds_read_b64_tr_b16 v[132:133], v27 offset:57344
    ds_read_b64_tr_b16 v[134:135], v27 offset:58368
    v_alignbit_b32 v249, v238, v237, 16
    v_mfma_f32_32x32x16_bf16 v[112:127], v[148:151], v[156:159], v[112:127]
    buffer_load_dwordx4 v14, s[28:31], s81 offen offset:2048 lds
    v_xor_b32 v63, s58, v213
    v_xor_b32 v215, s58, v215
    v_or_b32 v63, v63, v215
    v_cmp_ne_u32 vcc, 0, v63
    s_nop 1
    s_cbranch_vccnz L_rare0
L_back0:
    s_waitcnt lgkmcnt(8)
    v_mfma_f32_32x32x16_bf16 v[64:79], v[160:163], v[168:171], v[64:79]
    ds_read_b64_tr_b16 v[144:145], v26 offset:61440
    ds_read_b64_tr_b16 v[146:147], v26 offset:62464
    v_and_b32 v217, 0xffff0000, v212
    v_mfma_f32_16x16x32_bf16 a[244:247], v[160:163], a[240:243], a[244:247]
    v_mfma_f32_32x32x16_bf16 v[80:95], v[160:163], v[172:175], v[80:95]
    ds_read_b128 v[152:155], v23 offset:32768
    ds_read_b128 v[156:159], v23 offset:36864
    v_rcp_f32 v217, v217
    v_lshlrev_b32_e64 v216, 16, v212
    v_mfma_f32_32x32x16_bf16 v[96:111], v[164:167], v[168:171], v[96:111]
    ds_read_b64_tr_b16 v[148:149], v27 offset:61440
    ds_read_b64_tr_b16 v[150:151], v27 offset:62464
    v_mul_f32 v217, 0xbfb8aa3b, v217
    v_alignbit_b32 v250, v239, v238, 16
    v_mfma_f32_32x32x16_bf16 v[112:127], v[164:167], v[172:175], v[112:127]
    buffer_load_dwordx4 v15, s[28:31], s81 offen offset:3072 lds
    s_mov_b64 s[24:25], s[36:37]
    s_mov_b32 s92, 0xffffa000
    s_mov_b32 s56, s58
    s_mov_b32 s57, s58
    s_waitcnt lgkmcnt(6)
    v_mfma_f32_32x32x16_bf16 v[64:79], v[128:131], v[136:139], v[64:79]
    v_and_b32 v219, 0xffff0000, v214
    s_waitcnt vmcnt(9)
    v_alignbit_b32 v251, v241, v239, 16
    v_mfma_f32_16x16x32_bf16 a[244:247], v[128:131], a[240:243], a[244:247]
    v_rcp_f32 v219, v219
    s_waitcnt lgkmcnt(4)
    v_mfma_f32_16x16x32_bf16 a[244:247], v[144:147], a[240:243], a[244:247]
    v_mfma_f32_32x32x16_bf16 v[80:95], v[128:131], v[140:143], v[80:95]
    v_lshlrev_b32 v218, 16, v214
    v_mul_f32 v219, 0xbfb8aa3b, v219
    ds_write_b128 v242, v[248:251] offset:5184
    v_mfma_f32_32x32x16_bf16 v[96:111], v[132:135], v[136:139], v[96:111]
    s_nop 2
    ds_write_b128 v30, a[244:247]
    s_cmp_eq_u32 s83, 6
    s_cselect_b32 s96, s84, 0x8000
    s_add_u32 m0, s80, 32768
    s_add_u32 s81, s81, s96
    buffer_load_dwordx4 v12, s[28:31], s81 offen lds
    buffer_load_dwordx4 v13, s[28:31], s81 offen offset:1024 lds
    buffer_load_dwordx4 v14, s[28:31], s81 offen offset:2048 lds
    buffer_load_dwordx4 v15, s[28:31], s81 offen offset:3072 lds
    s_waitcnt lgkmcnt(0)
    v_mfma_f32_32x32x16_bf16 v[112:127], v[132:135], v[140:143], v[112:127]
    s_barrier
    ds_read_b128 v[176:179], v31 offset:0
    ds_read_b128 v[180:183], v31 offset:32
    ds_read_b128 v[184:187], v31 offset:64
    v_mfma_f32_32x32x16_bf16 v[64:79], v[144:147], v[152:155], v[64:79]
    ds_read_b128 v[188:191], v31 offset:96
    ds_read_b128 v[192:195], v32 offset:0
    ds_read_b128 v[196:199], v32 offset:32
    ds_read_b128 v[200:203], v32 offset:64
    ds_read_b128 v[204:207], v32 offset:96
    v_mfma_f32_32x32x16_bf16 v[80:95], v[144:147], v[156:159], v[80:95]
    v_mfma_f32_32x32x16_bf16 v[96:111], v[148:151], v[152:155], v[96:111]
    v_mfma_f32_32x32x16_bf16 v[112:127], v[148:151], v[156:159], v[112:127]
    s_waitcnt lgkmcnt(7)
    s_nop 2
    v_pk_fma_f32 v[64:65], v[176:177], v[216:217], v[64:65] op_sel_hi:[1,0,1] neg_lo:[0,1,0] neg_hi:[0,1,0]
    v_pk_fma_f32 v[66:67], v[178:179], v[216:217], v[66:67] op_sel_hi:[1,0,1] neg_lo:[0,1,0] neg_hi:[0,1,0]
    s_waitcnt lgkmcnt(6)
    v_pk_fma_f32 v[68:69], v[180:181], v[216:217], v[68:69] op_sel_hi:[1,0,1] neg_lo:[0,1,0] neg_hi:[0,1,0]
    v_pk_fma_f32 v[70:71], v[182:183], v[216:217], v[70:71] op_sel_hi:[1,0,1] neg_lo:[0,1,0] neg_hi:[0,1,0]
    v_pk_mul_f32 v[128:129], v[64:65], v[216:217] op_sel:[0,1] op_sel_hi:[1,1]
    v_pk_mul_f32 v[130:131], v[66:67], v[216:217] op_sel:[0,1] op_sel_hi:[1,1]
    v_pk_mul_f32 v[132:133], v[68:69], v[216:217] op_sel:[0,1] op_sel_hi:[1,1]
    v_pk_mul_f32 v[134:135], v[70:71], v[216:217] op_sel:[0,1] op_sel_hi:[1,1]
    s_add_u32 m0, s80, 36864
    s_add_u32 s81, s81, 32768
    buffer_load_dwordx4 v12, s[28:31], s81 offen lds
    v_exp_f32_e64 v128, v128
    v_exp_f32_e64 v129, v129
    v_exp_f32_e64 v130, v130
    v_exp_f32_e64 v131, v131
    v_exp_f32_e64 v132, v132
    v_exp_f32_e64 v133, v133
    v_exp_f32_e64 v134, v134
    v_exp_f32_e64 v135, v135
    buffer_load_dwordx4 v13, s[28:31], s81 offen offset:1024 lds
    v_pk_add_f32 v[128:129], v[128:129], 1.0 op_sel_hi:[1,0]
    v_pk_add_f32 v[130:131], v[130:131], 1.0 op_sel_hi:[1,0]
    v_pk_add_f32 v[132:133], v[132:133], 1.0 op_sel_hi:[1,0]
    v_pk_add_f32 v[134:135], v[134:135], 1.0 op_sel_hi:[1,0]
    v_rcp_f32_e64 v128, v128
    v_rcp_f32_e64 v129, v129
    v_rcp_f32_e64 v130, v130
    v_rcp_f32_e64 v131, v131
    buffer_load_dwordx4 v14, s[28:31], s81 offen offset:2048 lds
    v_rcp_f32_e64 v132, v132
    v_rcp_f32_e64 v133, v133
    v_rcp_f32_e64 v134, v134
    v_rcp_f32_e64 v135, v135
    v_pk_mul_f32 v[128:129], v[64:65], v[128:129]
    v_pk_mul_f32 v[130:131], v[66:67], v[130:131]
    v_pk_mul_f32 v[132:133], v[68:69], v[132:133]
    v_pk_mul_f32 v[134:135], v[70:71], v[134:135]
    buffer_load_dwordx4 v15, s[28:31], s81 offen offset:3072 lds
    v_cvt_pk_bf16_f32 v144, v128, v129
    v_cvt_pk_bf16_f32 v145, v130, v131
    v_cvt_pk_bf16_f32 v146, v132, v133
    v_cvt_pk_bf16_f32 v147, v134, v135
    s_load_dwordx16 s[64:79], s[36:37], s19 glc
    s_waitcnt lgkmcnt(5)
    v_pk_fma_f32 v[72:73], v[184:185], v[216:217], v[72:73] op_sel_hi:[1,0,1] neg_lo:[0,1,0] neg_hi:[0,1,0]
    v_pk_fma_f32 v[74:75], v[186:187], v[216:217], v[74:75] op_sel_hi:[1,0,1] neg_lo:[0,1,0] neg_hi:[0,1,0]
    s_waitcnt lgkmcnt(4)
    v_pk_fma_f32 v[76:77], v[188:189], v[216:217], v[76:77] op_sel_hi:[1,0,1] neg_lo:[0,1,0] neg_hi:[0,1,0]
    s_cmp_eq_u32 s83, 5
    s_cselect_b32 s96, s84, 0x8000
    s_add_u32 m0, s80, 65536
    s_add_u32 s81, s81, s96
    buffer_load_dwordx4 v12, s[28:31], s81 offen lds
    v_pk_fma_f32 v[78:79], v[190:191], v[216:217], v[78:79] op_sel_hi:[1,0,1] neg_lo:[0,1,0] neg_hi:[0,1,0]
    v_pk_mul_f32 v[136:137], v[72:73], v[216:217] op_sel:[0,1] op_sel_hi:[1,1]
    v_pk_mul_f32 v[138:139], v[74:75], v[216:217] op_sel:[0,1] op_sel_hi:[1,1]
    v_pk_mul_f32 v[140:141], v[76:77], v[216:217] op_sel:[0,1] op_sel_hi:[1,1]
    v_pk_mul_f32 v[142:143], v[78:79], v[216:217] op_sel:[0,1] op_sel_hi:[1,1]
    v_exp_f32_e64 v136, v136
    v_exp_f32_e64 v137, v137
    v_exp_f32_e64 v138, v138
    buffer_load_dwordx4 v13, s[28:31], s81 offen offset:1024 lds
    v_exp_f32_e64 v139, v139
    v_exp_f32_e64 v140, v140
    v_exp_f32_e64 v141, v141
    v_exp_f32_e64 v142, v142
    v_exp_f32_e64 v143, v143
    v_pk_add_f32 v[136:137], v[136:137], 1.0 op_sel_hi:[1,0]
    v_pk_add_f32 v[138:139], v[138:139], 1.0 op_sel_hi:[1,0]
    v_pk_add_f32 v[140:141], v[140:141], 1.0 op_sel_hi:[1,0]
    buffer_load_dwordx4 v14, s[28:31], s81 offen offset:2048 lds
    v_pk_add_f32 v[142:143], v[142:143], 1.0 op_sel_hi:[1,0]
    v_rcp_f32_e64 v136, v136
    v_rcp_f32_e64 v137, v137
    v_rcp_f32_e64 v138, v138
    v_rcp_f32_e64 v139, v139
    v_rcp_f32_e64 v140, v140
    v_rcp_f32_e64 v141, v141
    v_rcp_f32_e64 v142, v142
    buffer_load_dwordx4 v15, s[28:31], s81 offen offset:3072 lds
    v_rcp_f32_e64 v143, v143
    v_pk_mul_f32 v[136:137], v[72:73], v[136:137]
    v_pk_mul_f32 v[138:139], v[74:75], v[138:139]
    v_pk_mul_f32 v[140:141], v[76:77], v[140:141]
    v_pk_mul_f32 v[142:143], v[78:79], v[142:143]
    v_cvt_pk_bf16_f32 v148, v136, v137
    v_cvt_pk_bf16_f32 v149, v138, v139
    v_cvt_pk_bf16_f32 v150, v140, v141
    s_add_u32 m0, s80, 69632
    s_add_u32 s81, s81, 32768
    buffer_load_dwordx4 v12, s[28:31], s81 offen lds
    v_cvt_pk_bf16_f32 v151, v142, v143
    v_pk_fma_f32 v[80:81], v[176:177], v[218:219], v[80:81] op_sel_hi:[1,0,1] neg_lo:[0,1,0] neg_hi:[0,1,0]
    v_pk_fma_f32 v[82:83], v[178:179], v[218:219], v[82:83] op_sel_hi:[1,0,1] neg_lo:[0,1,0] neg_hi:[0,1,0]
    v_pk_fma_f32 v[84:85], v[180:181], v[218:219], v[84:85] op_sel_hi:[1,0,1] neg_lo:[0,1,0] neg_hi:[0,1,0]
    v_pk_fma_f32 v[86:87], v[182:183], v[218:219], v[86:87] op_sel_hi:[1,0,1] neg_lo:[0,1,0] neg_hi:[0,1,0]
    v_pk_mul_f32 v[128:129], v[80:81], v[218:219] op_sel:[0,1] op_sel_hi:[1,1]
    v_pk_mul_f32 v[130:131], v[82:83], v[218:219] op_sel:[0,1] op_sel_hi:[1,1]
    v_pk_mul_f32 v[132:133], v[84:85], v[218:219] op_sel:[0,1] op_sel_hi:[1,1]
    buffer_load_dwordx4 v13, s[28:31], s81 offen offset:1024 lds
    v_pk_mul_f32 v[134:135], v[86:87], v[218:219] op_sel:[0,1] op_sel_hi:[1,1]
    v_exp_f32_e64 v128, v128
    v_exp_f32_e64 v129, v129
    v_exp_f32_e64 v130, v130
    v_exp_f32_e64 v131, v131
    v_exp_f32_e64 v132, v132
    v_exp_f32_e64 v133, v133
    v_exp_f32_e64 v134, v134
    buffer_load_dwordx4 v14, s[28:31], s81 offen offset:2048 lds
    v_exp_f32_e64 v135, v135
    v_pk_add_f32 v[128:129], v[128:129], 1.0 op_sel_hi:[1,0]
    v_pk_add_f32 v[130:131], v[130:131], 1.0 op_sel_hi:[1,0]
    v_pk_add_f32 v[132:133], v[132:133], 1.0 op_sel_hi:[1,0]
    v_pk_add_f32 v[134:135], v[134:135], 1.0 op_sel_hi:[1,0]
    v_rcp_f32_e64 v128, v128
    v_rcp_f32_e64 v129, v129
    v_rcp_f32_e64 v130, v130
    buffer_load_dwordx4 v15, s[28:31], s81 offen offset:3072 lds
    v_rcp_f32_e64 v131, v131
    v_rcp_f32_e64 v132, v132
    v_rcp_f32_e64 v133, v133
    v_rcp_f32_e64 v134, v134
    v_rcp_f32_e64 v135, v135
    v_pk_mul_f32 v[128:129], v[80:81], v[128:129]
    v_pk_mul_f32 v[130:131], v[82:83], v[130:131]
    v_pk_mul_f32 v[132:133], v[84:85], v[132:133]
    v_pk_mul_f32 v[134:135], v[86:87], v[134:135]
    v_cvt_pk_bf16_f32 v152, v128, v129
    v_cvt_pk_bf16_f32 v153, v130, v131
    v_cvt_pk_bf16_f32 v154, v132, v133
    v_cvt_pk_bf16_f32 v155, v134, v135
    v_pk_fma_f32 v[88:89], v[184:185], v[218:219], v[88:89] op_sel_hi:[1,0,1] neg_lo:[0,1,0] neg_hi:[0,1,0]
    v_pk_fma_f32 v[90:91], v[186:187], v[218:219], v[90:91] op_sel_hi:[1,0,1] neg_lo:[0,1,0] neg_hi:[0,1,0]
    v_pk_fma_f32 v[92:93], v[188:189], v[218:219], v[92:93] op_sel_hi:[1,0,1] neg_lo:[0,1,0] neg_hi:[0,1,0]
    v_pk_fma_f32 v[94:95], v[190:191], v[218:219], v[94:95] op_sel_hi:[1,0,1] neg_lo:[0,1,0] neg_hi:[0,1,0]
    v_pk_mul_f32 v[136:137], v[88:89], v[218:219] op_sel:[0,1] op_sel_hi:[1,1]
    v_pk_mul_f32 v[138:139], v[90:91], v[218:219] op_sel:[0,1] op_sel_hi:[1,1]
    v_pk_mul_f32 v[140:141], v[92:93], v[218:219] op_sel:[0,1] op_sel_hi:[1,1]
    v_pk_mul_f32 v[142:143], v[94:95], v[218:219] op_sel:[0,1] op_sel_hi:[1,1]
    v_exp_f32_e64 v136, v136
    v_exp_f32_e64 v137, v137
    v_exp_f32_e64 v138, v138
    v_exp_f32_e64 v139, v139
    v_exp_f32_e64 v140, v140
    v_exp_f32_e64 v141, v141
    v_exp_f32_e64 v142, v142
    v_exp_f32_e64 v143, v143
    v_pk_add_f32 v[136:137], v[136:137], 1.0 op_sel_hi:[1,0]
    v_pk_add_f32 v[138:139], v[138:139], 1.0 op_sel_hi:[1,0]
    v_pk_add_f32 v[140:141], v[140:141], 1.0 op_sel_hi:[1,0]
    v_pk_add_f32 v[142:143], v[142:143], 1.0 op_sel_hi:[1,0]
    v_rcp_f32_e64 v136, v136
    v_rcp_f32_e64 v137, v137
    v_rcp_f32_e64 v138, v138
    v_rcp_f32_e64 v139, v139
    v_rcp_f32_e64 v140, v140
    v_rcp_f32_e64 v141, v141
    v_rcp_f32_e64 v142, v142
    v_rcp_f32_e64 v143, v143
    v_pk_mul_f32 v[136:137], v[88:89], v[136:137]
    v_pk_mul_f32 v[138:139], v[90:91], v[138:139]
    v_pk_mul_f32 v[140:141], v[92:93], v[140:141]
    v_pk_mul_f32 v[142:143], v[94:95], v[142:143]
    v_cvt_pk_bf16_f32 v156, v136, v137
    v_cvt_pk_bf16_f32 v157, v138, v139
    v_cvt_pk_bf16_f32 v158, v140, v141
    v_cvt_pk_bf16_f32 v159, v142, v143
    s_waitcnt lgkmcnt(0)
    s_xor_b64 s[64:65], s[64:65], s[56:57]
    s_xor_b64 s[66:67], s[66:67], s[56:57]
    s_or_b64 s[64:65], s[64:65], s[66:67]
    s_xor_b64 s[68:69], s[68:69], s[56:57]
    s_or_b64 s[64:65], s[64:65], s[68:69]
    s_xor_b64 s[70:71], s[70:71], s[56:57]
    s_or_b64 s[64:65], s[64:65], s[70:71]
    s_xor_b64 s[72:73], s[72:73], s[56:57]
    s_or_b64 s[64:65], s[64:65], s[72:73]
    s_xor_b64 s[74:75], s[74:75], s[56:57]
    s_or_b64 s[64:65], s[64:65], s[74:75]
    s_xor_b64 s[76:77], s[76:77], s[56:57]
    s_or_b64 s[64:65], s[64:65], s[76:77]
    s_xor_b64 s[78:79], s[78:79], s[56:57]
    s_or_b64 s[64:65], s[64:65], s[78:79]
    s_cselect_b32 s26, 0, 12582912
    s_cselect_b32 s40, 1, 0
    buffer_load_dwordx4 v[220:223], v2, s[24:27], s20 offen sc1
    buffer_load_dwordx4 v[224:227], v2, s[24:27], s20 offen offset:1024 sc1
    v_pk_fma_f32 v[96:97], v[192:193], v[216:217], v[96:97] op_sel_hi:[1,0,1] neg_lo:[0,1,0] neg_hi:[0,1,0]
    v_pk_fma_f32 v[98:99], v[194:195], v[216:217], v[98:99] op_sel_hi:[1,0,1] neg_lo:[0,1,0] neg_hi:[0,1,0]
    v_pk_fma_f32 v[100:101], v[196:197], v[216:217], v[100:101] op_sel_hi:[1,0,1] neg_lo:[0,1,0] neg_hi:[0,1,0]
    v_pk_fma_f32 v[102:103], v[198:199], v[216:217], v[102:103] op_sel_hi:[1,0,1] neg_lo:[0,1,0] neg_hi:[0,1,0]
    v_pk_mul_f32 v[128:129], v[96:97], v[216:217] op_sel:[0,1] op_sel_hi:[1,1]
    v_pk_mul_f32 v[130:131], v[98:99], v[216:217] op_sel:[0,1] op_sel_hi:[1,1]
    v_pk_mul_f32 v[132:133], v[100:101], v[216:217] op_sel:[0,1] op_sel_hi:[1,1]
    v_pk_mul_f32 v[134:135], v[102:103], v[216:217] op_sel:[0,1] op_sel_hi:[1,1]
    v_exp_f32_e64 v128, v128
    v_exp_f32_e64 v129, v129
    v_exp_f32_e64 v130, v130
    v_exp_f32_e64 v131, v131
    v_exp_f32_e64 v132, v132
    v_exp_f32_e64 v133, v133
    v_exp_f32_e64 v134, v134
    v_exp_f32_e64 v135, v135
    buffer_store_dwordx4 v[144:147], v2, s[36:39], s88 offen sc1
    v_pk_add_f32 v[128:129], v[128:129], 1.0 op_sel_hi:[1,0]
    v_pk_add_f32 v[130:131], v[130:131], 1.0 op_sel_hi:[1,0]
    v_pk_add_f32 v[132:133], v[132:133], 1.0 op_sel_hi:[1,0]
    v_pk_add_f32 v[134:135], v[134:135], 1.0 op_sel_hi:[1,0]
    v_rcp_f32_e64 v128, v128
    v_rcp_f32_e64 v129, v129
    v_rcp_f32_e64 v130, v130
    v_rcp_f32_e64 v131, v131
    v_rcp_f32_e64 v132, v132
    v_rcp_f32_e64 v133, v133
    v_rcp_f32_e64 v134, v134
    v_rcp_f32_e64 v135, v135
    buffer_store_dwordx4 v[148:151], v2, s[36:39], s88 offen offset:1024 sc1
    v_pk_mul_f32 v[128:129], v[96:97], v[128:129]
    v_pk_mul_f32 v[130:131], v[98:99], v[130:131]
    v_pk_mul_f32 v[132:133], v[100:101], v[132:133]
    v_pk_mul_f32 v[134:135], v[102:103], v[134:135]
    v_cvt_pk_bf16_f32 v160, v128, v129
    v_cvt_pk_bf16_f32 v161, v130, v131
    v_cvt_pk_bf16_f32 v162, v132, v133
    v_cvt_pk_bf16_f32 v163, v134, v135
    buffer_store_dwordx4 v[160:163], v2, s[36:39], s90 offen sc1
    v_pk_fma_f32 v[104:105], v[200:201], v[216:217], v[104:105] op_sel_hi:[1,0,1] neg_lo:[0,1,0] neg_hi:[0,1,0]
    v_pk_fma_f32 v[106:107], v[202:203], v[216:217], v[106:107] op_sel_hi:[1,0,1] neg_lo:[0,1,0] neg_hi:[0,1,0]
    v_pk_fma_f32 v[108:109], v[204:205], v[216:217], v[108:109] op_sel_hi:[1,0,1] neg_lo:[0,1,0] neg_hi:[0,1,0]
    v_pk_fma_f32 v[110:111], v[206:207], v[216:217], v[110:111] op_sel_hi:[1,0,1] neg_lo:[0,1,0] neg_hi:[0,1,0]
    v_pk_mul_f32 v[136:137], v[104:105], v[216:217] op_sel:[0,1] op_sel_hi:[1,1]
    v_pk_mul_f32 v[138:139], v[106:107], v[216:217] op_sel:[0,1] op_sel_hi:[1,1]
    v_pk_mul_f32 v[140:141], v[108:109], v[216:217] op_sel:[0,1] op_sel_hi:[1,1]
    v_pk_mul_f32 v[142:143], v[110:111], v[216:217] op_sel:[0,1] op_sel_hi:[1,1]
    v_exp_f32_e64 v136, v136
    v_exp_f32_e64 v137, v137
    v_exp_f32_e64 v138, v138
    v_exp_f32_e64 v139, v139
    v_exp_f32_e64 v140, v140
    v_exp_f32_e64 v141, v141
    v_exp_f32_e64 v142, v142
    v_exp_f32_e64 v143, v143
    buffer_store_dwordx4 v[152:155], v2, s[36:39], s89 offen sc1
    v_pk_add_f32 v[136:137], v[136:137], 1.0 op_sel_hi:[1,0]
    v_pk_add_f32 v[138:139], v[138:139], 1.0 op_sel_hi:[1,0]
    v_pk_add_f32 v[140:141], v[140:141], 1.0 op_sel_hi:[1,0]
    v_pk_add_f32 v[142:143], v[142:143], 1.0 op_sel_hi:[1,0]
    v_rcp_f32_e64 v136, v136
    v_rcp_f32_e64 v137, v137
    v_rcp_f32_e64 v138, v138
    v_rcp_f32_e64 v139, v139
    v_rcp_f32_e64 v140, v140
    v_rcp_f32_e64 v141, v141
    v_rcp_f32_e64 v142, v142
    v_rcp_f32_e64 v143, v143
    buffer_store_dwordx4 v[156:159], v2, s[36:39], s89 offen offset:1024 sc1
    v_pk_mul_f32 v[136:137], v[104:105], v[136:137]
    v_pk_mul_f32 v[138:139], v[106:107], v[138:139]
    v_pk_mul_f32 v[140:141], v[108:109], v[140:141]
    v_pk_mul_f32 v[142:143], v[110:111], v[142:143]
    v_cvt_pk_bf16_f32 v164, v136, v137
    v_cvt_pk_bf16_f32 v165, v138, v139
    v_cvt_pk_bf16_f32 v166, v140, v141
    v_cvt_pk_bf16_f32 v167, v142, v143
    buffer_store_dwordx4 v[164:167], v2, s[36:39], s90 offen offset:1024 sc1
    v_pk_fma_f32 v[112:113], v[192:193], v[218:219], v[112:113] op_sel_hi:[1,0,1] neg_lo:[0,1,0] neg_hi:[0,1,0]
    v_pk_fma_f32 v[114:115], v[194:195], v[218:219], v[114:115] op_sel_hi:[1,0,1] neg_lo:[0,1,0] neg_hi:[0,1,0]
    v_pk_fma_f32 v[116:117], v[196:197], v[218:219], v[116:117] op_sel_hi:[1,0,1] neg_lo:[0,1,0] neg_hi:[0,1,0]
    v_pk_fma_f32 v[118:119], v[198:199], v[218:219], v[118:119] op_sel_hi:[1,0,1] neg_lo:[0,1,0] neg_hi:[0,1,0]
    v_pk_mul_f32 v[128:129], v[112:113], v[218:219] op_sel:[0,1] op_sel_hi:[1,1]
    v_pk_mul_f32 v[130:131], v[114:115], v[218:219] op_sel:[0,1] op_sel_hi:[1,1]
    v_pk_mul_f32 v[132:133], v[116:117], v[218:219] op_sel:[0,1] op_sel_hi:[1,1]
    v_pk_mul_f32 v[134:135], v[118:119], v[218:219] op_sel:[0,1] op_sel_hi:[1,1]
    v_exp_f32_e64 v128, v128
    v_exp_f32_e64 v129, v129
    v_exp_f32_e64 v130, v130
    v_exp_f32_e64 v131, v131
    v_exp_f32_e64 v132, v132
    v_exp_f32_e64 v133, v133
    v_exp_f32_e64 v134, v134
    v_exp_f32_e64 v135, v135
    v_pk_add_f32 v[128:129], v[128:129], 1.0 op_sel_hi:[1,0]
    v_pk_add_f32 v[130:131], v[130:131], 1.0 op_sel_hi:[1,0]
    v_pk_add_f32 v[132:133], v[132:133], 1.0 op_sel_hi:[1,0]
    v_pk_add_f32 v[134:135], v[134:135], 1.0 op_sel_hi:[1,0]
    v_rcp_f32_e64 v128, v128
    v_rcp_f32_e64 v129, v129
    v_rcp_f32_e64 v130, v130
    v_rcp_f32_e64 v131, v131
    v_rcp_f32_e64 v132, v132
    v_rcp_f32_e64 v133, v133
    v_rcp_f32_e64 v134, v134
    v_rcp_f32_e64 v135, v135
    v_pk_mul_f32 v[128:129], v[112:113], v[128:129]
    v_pk_mul_f32 v[130:131], v[114:115], v[130:131]
    v_pk_mul_f32 v[132:133], v[116:117], v[132:133]
    v_pk_mul_f32 v[134:135], v[118:119], v[134:135]
    v_cvt_pk_bf16_f32 v168, v128, v129
    v_cvt_pk_bf16_f32 v169, v130, v131
    v_cvt_pk_bf16_f32 v170, v132, v133
    v_cvt_pk_bf16_f32 v171, v134, v135
    buffer_store_dwordx4 v[168:171], v2, s[36:39], s91 offen sc1
    v_pk_fma_f32 v[120:121], v[200:201], v[218:219], v[120:121] op_sel_hi:[1,0,1] neg_lo:[0,1,0] neg_hi:[0,1,0]
    v_pk_fma_f32 v[122:123], v[202:203], v[218:219], v[122:123] op_sel_hi:[1,0,1] neg_lo:[0,1,0] neg_hi:[0,1,0]
    v_pk_fma_f32 v[124:125], v[204:205], v[218:219], v[124:125] op_sel_hi:[1,0,1] neg_lo:[0,1,0] neg_hi:[0,1,0]
    v_pk_fma_f32 v[126:127], v[206:207], v[218:219], v[126:127] op_sel_hi:[1,0,1] neg_lo:[0,1,0] neg_hi:[0,1,0]
    v_pk_mul_f32 v[136:137], v[120:121], v[218:219] op_sel:[0,1] op_sel_hi:[1,1]
    v_pk_mul_f32 v[138:139], v[122:123], v[218:219] op_sel:[0,1] op_sel_hi:[1,1]
    v_pk_mul_f32 v[140:141], v[124:125], v[218:219] op_sel:[0,1] op_sel_hi:[1,1]
    v_pk_mul_f32 v[142:143], v[126:127], v[218:219] op_sel:[0,1] op_sel_hi:[1,1]
    v_exp_f32_e64 v136, v136
    v_exp_f32_e64 v137, v137
    v_exp_f32_e64 v138, v138
    v_exp_f32_e64 v139, v139
    v_exp_f32_e64 v140, v140
    v_exp_f32_e64 v141, v141
    v_exp_f32_e64 v142, v142
    v_exp_f32_e64 v143, v143
    v_pk_add_f32 v[136:137], v[136:137], 1.0 op_sel_hi:[1,0]
    v_pk_add_f32 v[138:139], v[138:139], 1.0 op_sel_hi:[1,0]
    v_pk_add_f32 v[140:141], v[140:141], 1.0 op_sel_hi:[1,0]
    v_pk_add_f32 v[142:143], v[142:143], 1.0 op_sel_hi:[1,0]
    v_rcp_f32_e64 v136, v136
    v_rcp_f32_e64 v137, v137
    v_rcp_f32_e64 v138, v138
    v_rcp_f32_e64 v139, v139
    v_rcp_f32_e64 v140, v140
    v_rcp_f32_e64 v141, v141
    v_rcp_f32_e64 v142, v142
    v_rcp_f32_e64 v143, v143
    v_pk_mul_f32 v[136:137], v[120:121], v[136:137]
    v_pk_mul_f32 v[138:139], v[122:123], v[138:139]
    v_pk_mul_f32 v[140:141], v[124:125], v[140:141]
    v_pk_mul_f32 v[142:143], v[126:127], v[142:143]
    v_cvt_pk_bf16_f32 v172, v136, v137
    v_cvt_pk_bf16_f32 v173, v138, v139
    v_cvt_pk_bf16_f32 v174, v140, v141
    v_cvt_pk_bf16_f32 v175, v142, v143
    buffer_store_dwordx4 v[172:175], v2, s[36:39], s91 offen offset:1024 sc1
L_join:
    s_cmp_lg_u32 s40, 0
    s_cbranch_scc1 L_rare2
L_back2:
    s_waitcnt vmcnt(9)
    ds_write_b128 v42, v[220:223]
    s_waitcnt vmcnt(8)
    ds_write_b128 v42, v[224:227] offset:1024
    s_waitcnt lgkmcnt(0)
    s_barrier
    ds_read2_b32 v[128:129], v37 offset0:0 offset1:1
    ds_read2_b32 v[130:131], v37 offset0:2 offset1:3
    ds_read_b128 v[188:191], v41 offset:3584
    ds_read_b128 v[184:187], v41 offset:3072
    ds_read_b128 v[180:183], v41 offset:2560
    ds_read_b128 v[176:179], v41 offset:2048
    s_waitcnt lgkmcnt(3)
    v_mfma_f32_16x16x32_bf16 v[64:67], v[128:131], v[188:191], 0
    ds_read_b128 v[172:175], v41 offset:1536
    ds_read_b128 v[168:171], v41 offset:1024
    s_waitcnt lgkmcnt(4)
    v_mfma_f32_16x16x32_bf16 v[68:71], v[128:131], v[184:187], 0
    ds_read_b128 v[164:167], v41 offset:512
    ds_read_b128 v[160:163], v41 offset:0
    s_cmp_eq_u32 s83, 4
    s_cselect_b32 s96, s84, 0x8000
    s_add_u32 m0, s80, 98304
    s_add_u32 s81, s81, s96
    buffer_load_dwordx4 v12, s[28:31], s81 offen lds
    s_waitcnt lgkmcnt(5)
    v_mfma_f32_16x16x32_bf16 v[72:75], v[128:131], v[180:183], 0
    ds_read2_b32 v[132:133], v37 offset0:128 offset1:129
    s_waitcnt lgkmcnt(5)
    v_mfma_f32_16x16x32_bf16 v[76:79], v[128:131], v[176:179], 0
    ds_read2_b32 v[134:135], v37 offset0:130 offset1:131
    s_waitcnt lgkmcnt(5)
    v_mfma_f32_16x16x32_bf16 v[80:83], v[128:131], v[172:175], 0
    ds_read2_b32 v[136:137], v38 offset0:0 offset1:1
    s_waitcnt lgkmcnt(5)
    v_mfma_f32_16x16x32_bf16 v[84:87], v[128:131], v[168:171], 0
    ds_read2_b32 v[138:139], v38 offset0:2 offset1:3
    buffer_load_dwordx4 v13, s[28:31], s81 offen offset:1024 lds
    s_waitcnt lgkmcnt(5)
    v_mfma_f32_16x16x32_bf16 v[88:91], v[128:131], v[164:167], 0
    ds_read2_b32 v[140:141], v38 offset0:128 offset1:129
    s_waitcnt lgkmcnt(5)
    v_mfma_f32_16x16x32_bf16 v[92:95], v[128:131], v[160:163], 0
    ds_read2_b32 v[142:143], v38 offset0:130 offset1:131
    s_waitcnt lgkmcnt(4)
    v_mfma_f32_16x16x32_bf16 v[68:71], v[132:135], v[188:191], v[68:71]
    ds_read2_b32 v[144:145], v39 offset0:0 offset1:1
    v_mfma_f32_16x16x32_bf16 v[72:75], v[132:135], v[184:187], v[72:75]
    ds_read2_b32 v[146:147], v39 offset0:2 offset1:3
    buffer_load_dwordx4 v14, s[28:31], s81 offen offset:2048 lds
    v_mfma_f32_16x16x32_bf16 v[76:79], v[132:135], v[180:183], v[76:79]
    ds_read2_b32 v[148:149], v39 offset0:128 offset1:129
    ds_read_b64_tr_b16 a[0:1], v33 offset:0
    v_mfma_f32_16x16x32_bf16 v[80:83], v[132:135], v[176:179], v[80:83]
    ds_read2_b32 v[150:151], v39 offset0:130 offset1:131
    ds_read_b64_tr_b16 a[2:3], v33 offset:1024
    v_mfma_f32_16x16x32_bf16 v[84:87], v[132:135], v[172:175], v[84:87]
    ds_read2_b32 v[152:153], v40 offset0:0 offset1:1
    ds_read_b64_tr_b16 a[4:5], v34 offset:0
    v_mfma_f32_16x16x32_bf16 v[88:91], v[132:135], v[168:171], v[88:91]
    ds_read2_b32 v[154:155], v40 offset0:2 offset1:3
    buffer_load_dwordx4 v15, s[28:31], s81 offen offset:3072 lds
    v_mfma_f32_16x16x32_bf16 v[92:95], v[132:135], v[164:167], v[92:95]
    ds_read2_b32 v[156:157], v40 offset0:128 offset1:129
    ds_read_b64_tr_b16 a[6:7], v34 offset:1024
    s_waitcnt lgkmcnt(13)
    v_mfma_f32_16x16x32_bf16 v[72:75], v[136:139], v[188:191], v[72:75]
    ds_read2_b32 v[158:159], v40 offset0:130 offset1:131
    ds_read_b64_tr_b16 a[8:9], v33 offset:2048
    v_mfma_f32_16x16x32_bf16 v[76:79], v[136:139], v[184:187], v[76:79]
    ds_read2_b32 v[192:193], v37 offset0:32 offset1:33
    ds_read_b64_tr_b16 a[10:11], v33 offset:3072
    v_mfma_f32_16x16x32_bf16 v[80:83], v[136:139], v[180:183], v[80:83]
    ds_read2_b32 v[194:195], v37 offset0:34 offset1:35
    s_add_u32 m0, s80, 102400
    s_add_u32 s81, s81, 32768
    buffer_load_dwordx4 v12, s[28:31], s81 offen lds
    v_mfma_f32_16x16x32_bf16 v[84:87], v[136:139], v[176:179], v[84:87]
    ds_read_b128 v[252:255], v41 offset:3712
    v_mfma_f32_16x16x32_bf16 v[88:91], v[136:139], v[172:175], v[88:91]
    ds_read_b128 v[248:251], v41 offset:3200
    v_mfma_f32_16x16x32_bf16 v[92:95], v[136:139], v[168:171], v[92:95]
    ds_read_b128 v[244:247], v41 offset:2688
    ds_read_b64_tr_b16 a[12:13], v34 offset:2048
    s_waitcnt lgkmcnt(15)
    v_mfma_f32_16x16x32_bf16 v[76:79], v[140:143], v[188:191], v[76:79]
    ds_read_b128 v[240:243], v41 offset:2176
    buffer_load_dwordx4 v13, s[28:31], s81 offen offset:1024 lds
    v_mfma_f32_16x16x32_bf16 v[80:83], v[140:143], v[184:187], v[80:83]
    ds_read_b128 v[236:239], v41 offset:1664
    ds_read_b64_tr_b16 a[14:15], v34 offset:3072
    v_mfma_f32_16x16x32_bf16 v[84:87], v[140:143], v[180:183], v[84:87]
    ds_read_b128 v[232:235], v41 offset:1152
    ds_read_b64_tr_b16 a[16:17], v33 offset:4096
    v_mfma_f32_16x16x32_bf16 v[88:91], v[140:143], v[176:179], v[88:91]
    ds_read_b128 v[228:231], v41 offset:640
    ds_read_b64_tr_b16 a[18:19], v33 offset:5120
    ds_read_b64_tr_b16 a[20:21], v34 offset:4096
    ds_read_b64_tr_b16 a[22:23], v34 offset:5120
    ds_read_b64_tr_b16 a[24:25], v33 offset:6144
    ds_read_b64_tr_b16 a[26:27], v33 offset:7168
    ds_read_b64_tr_b16 a[28:29], v34 offset:6144
    ds_read_b64_tr_b16 a[30:31], v34 offset:7168
    v_mfma_f32_16x16x32_bf16 v[92:95], v[140:143], v[172:175], v[92:95]
    ds_read_b128 v[224:227], v41 offset:128
    buffer_load_dwordx4 v14, s[28:31], s81 offen offset:2048 lds
    v_mfma_f32_16x16x32_bf16 v[80:83], v[144:147], v[188:191], v[80:83]
    ds_read2_b32 v[196:197], v37 offset0:160 offset1:161
    ds_read_b64_tr_b16 a[32:33], v33 offset:32768
    v_mfma_f32_16x16x32_bf16 v[84:87], v[144:147], v[184:187], v[84:87]
    ds_read2_b32 v[198:199], v37 offset0:162 offset1:163
    ds_read_b64_tr_b16 a[34:35], v33 offset:33792
    v_mfma_f32_16x16x32_bf16 v[88:91], v[144:147], v[180:183], v[88:91]
    ds_read2_b32 v[200:201], v38 offset0:32 offset1:33
    ds_read_b64_tr_b16 a[36:37], v34 offset:32768
    v_mfma_f32_16x16x32_bf16 v[92:95], v[144:147], v[176:179], v[92:95]
    ds_read2_b32 v[202:203], v38 offset0:34 offset1:35
    buffer_load_dwordx4 v15, s[28:31], s81 offen offset:3072 lds
    v_mfma_f32_16x16x32_bf16 v[84:87], v[148:151], v[188:191], v[84:87]
    ds_read2_b32 v[204:205], v38 offset0:160 offset1:161
    ds_read_b64_tr_b16 a[38:39], v34 offset:33792
    v_mfma_f32_16x16x32_bf16 v[88:91], v[148:151], v[184:187], v[88:91]
    ds_read2_b32 v[206:207], v38 offset0:162 offset1:163
    ds_read_b64_tr_b16 a[40:41], v33 offset:34816
    v_mfma_f32_16x16x32_bf16 v[92:95], v[148:151], v[180:183], v[92:95]
    ds_read2_b32 v[208:209], v39 offset0:32 offset1:33
    ds_read_b64_tr_b16 a[42:43], v33 offset:35840
    s_waitcnt lgkmcnt(15)
    v_mfma_f32_16x16x32_bf16 v[88:91], v[152:155], v[188:191], v[88:91]
    ds_read2_b32 v[210:211], v39 offset0:34 offset1:35
    ds_read_b64_tr_b16 a[44:45], v34 offset:34816
    v_mfma_f32_16x16x32_bf16 v[92:95], v[152:155], v[184:187], v[92:95]
    ds_read2_b32 v[212:213], v39 offset0:160 offset1:161
    ds_read_b64_tr_b16 a[46:47], v34 offset:35840
    v_mfma_f32_16x16x32_bf16 v[92:95], v[156:159], v[188:191], v[92:95]
    ds_read2_b32 v[214:215], v39 offset0:162 offset1:163
    ds_read_b64_tr_b16 a[48:49], v33 offset:36864
    ds_read2_b32 v[216:217], v40 offset0:32 offset1:33
    ds_read2_b32 v[218:219], v40 offset0:34 offset1:35
    ds_read2_b32 v[220:221], v40 offset0:160 offset1:161
    ds_read2_b32 v[222:223], v40 offset0:162 offset1:163
    s_waitcnt lgkmcnt(0)
    v_mfma_f32_16x16x32_bf16 v[64:67], v[192:195], v[252:255], v[64:67]
    ds_read_b64_tr_b16 a[50:51], v33 offset:37888
    ds_read_b64_tr_b16 a[52:53], v34 offset:36864
    v_mfma_f32_16x16x32_bf16 v[68:71], v[192:195], v[248:251], v[68:71]
    ds_read2_b32 v[128:129], v37 offset0:64 offset1:65
    ds_read_b64_tr_b16 a[54:55], v34 offset:37888
    v_mfma_f32_16x16x32_bf16 v[72:75], v[192:195], v[244:247], v[72:75]
    ds_read2_b32 v[130:131], v37 offset0:66 offset1:67
    ds_read_b64_tr_b16 a[56:57], v33 offset:38912
    v_mfma_f32_16x16x32_bf16 v[76:79], v[192:195], v[240:243], v[76:79]
    ds_read_b64_tr_b16 a[58:59], v33 offset:39936
    ds_read_b64_tr_b16 a[60:61], v34 offset:38912
    v_mfma_f32_16x16x32_bf16 v[80:83], v[192:195], v[236:239], v[80:83]
    ds_read_b128 v[188:191], v41 offset:3840
    ds_read_b64_tr_b16 a[62:63], v34 offset:39936
    v_mfma_f32_16x16x32_bf16 v[84:87], v[192:195], v[232:235], v[84:87]
    ds_read_b128 v[184:187], v41 offset:3328
    s_cmp_eq_u32 s83, 3
    s_cselect_b32 s96, s84, 0x8000
    s_add_u32 m0, s80, 0
    s_add_u32 s81, s81, s96
    buffer_load_dwordx4 v12, s[28:31], s81 offen lds
    v_mfma_f32_16x16x32_bf16 v[88:91], v[192:195], v[228:231], v[88:91]
    ds_read_b128 v[180:183], v41 offset:2816
    v_mfma_f32_16x16x32_bf16 v[92:95], v[192:195], v[224:227], v[92:95]
    v_mfma_f32_16x16x32_bf16 v[68:71], v[196:199], v[252:255], v[68:71]
    ds_read_b128 v[176:179], v41 offset:2304
    v_mfma_f32_16x16x32_bf16 v[72:75], v[196:199], v[248:251], v[72:75]
    ds_read_b128 v[172:175], v41 offset:1792
    buffer_load_dwordx4 v13, s[28:31], s81 offen offset:1024 lds
    v_mfma_f32_16x16x32_bf16 v[76:79], v[196:199], v[244:247], v[76:79]
    ds_read_b128 v[168:171], v41 offset:1280
    ds_read_b64_tr_b16 a[64:65], v35 offset:0
    v_mfma_f32_16x16x32_bf16 v[80:83], v[196:199], v[240:243], v[80:83]
    ds_read_b64_tr_b16 a[66:67], v35 offset:1024
    ds_read_b64_tr_b16 a[68:69], v36 offset:0
    v_mfma_f32_16x16x32_bf16 v[84:87], v[196:199], v[236:239], v[84:87]
    ds_read_b128 v[164:167], v41 offset:768
    ds_read_b64_tr_b16 a[70:71], v36 offset:1024
    v_mfma_f32_16x16x32_bf16 v[88:91], v[196:199], v[232:235], v[88:91]
    ds_read_b128 v[160:163], v41 offset:256
    buffer_load_dwordx4 v14, s[28:31], s81 offen offset:2048 lds
    v_mfma_f32_16x16x32_bf16 v[92:95], v[196:199], v[228:231], v[92:95]
    ds_read2_b32 v[132:133], v37 offset0:192 offset1:193
    s_nop 1
    s_getreg_b32 s50, hwreg(HW_REG_IB_STS)
    s_and_b32 s50, s50, 0xc0000f
    s_or_b32 s50, s50, s87
    s_cmp_le_u32 s50, 0xb
    s_cselect_b32 s50, 12582912, 0
    s_cselect_b32 s87, 0x80000000, s87
    buffer_store_dword v28, v3, s[48:51], s21 offen sc1
    v_mfma_f32_16x16x32_bf16 v[72:75], v[200:203], v[252:255], v[72:75]
    v_mfma_f32_16x16x32_bf16 v[76:79], v[200:203], v[248:251], v[76:79]
    ds_read2_b32 v[134:135], v37 offset0:194 offset1:195
    v_mfma_f32_16x16x32_bf16 v[80:83], v[200:203], v[244:247], v[80:83]
    ds_read2_b32 v[136:137], v38 offset0:64 offset1:65
    buffer_load_dwordx4 v15, s[28:31], s81 offen offset:3072 lds
    v_mfma_f32_16x16x32_bf16 v[84:87], v[200:203], v[240:243], v[84:87]
    ds_read2_b32 v[138:139], v38 offset0:66 offset1:67
    v_mfma_f32_16x16x32_bf16 v[88:91], v[200:203], v[236:239], v[88:91]
    ds_read_b64_tr_b16 a[72:73], v35 offset:2048
    v_mfma_f32_16x16x32_bf16 v[92:95], v[200:203], v[232:235], v[92:95]
    ds_read2_b32 v[140:141], v38 offset0:192 offset1:193
    ds_read_b64_tr_b16 a[74:75], v35 offset:3072
    ds_read_b64_tr_b16 a[76:77], v36 offset:2048
    ds_read_b64_tr_b16 a[78:79], v36 offset:3072
    ds_read_b64_tr_b16 a[80:81], v35 offset:4096
    ds_read_b64_tr_b16 a[82:83], v35 offset:5120
    ds_read_b64_tr_b16 a[84:85], v36 offset:4096
    ds_read_b64_tr_b16 a[86:87], v36 offset:5120
    ds_read_b64_tr_b16 a[88:89], v35 offset:6144
    ds_read_b64_tr_b16 a[90:91], v35 offset:7168
    ds_read_b64_tr_b16 a[92:93], v36 offset:6144
    ds_read_b64_tr_b16 a[94:95], v36 offset:7168
    v_mfma_f32_16x16x32_bf16 v[76:79], v[204:207], v[252:255], v[76:79]
    ds_read2_b32 v[142:143], v38 offset0:194 offset1:195
    s_add_u32 m0, s80, 4096
    s_add_u32 s81, s81, 32768
    buffer_load_dwordx4 v12, s[28:31], s81 offen lds
    v_mfma_f32_16x16x32_bf16 v[80:83], v[204:207], v[248:251], v[80:83]
    ds_read2_b32 v[144:145], v39 offset0:64 offset1:65
    v_mfma_f32_16x16x32_bf16 v[84:87], v[204:207], v[244:247], v[84:87]
    v_mfma_f32_16x16x32_bf16 v[88:91], v[204:207], v[240:243], v[88:91]
    ds_read2_b32 v[146:147], v39 offset0:66 offset1:67
    v_mfma_f32_16x16x32_bf16 v[92:95], v[204:207], v[236:239], v[92:95]
    ds_read2_b32 v[148:149], v39 offset0:192 offset1:193
    buffer_load_dwordx4 v13, s[28:31], s81 offen offset:1024 lds
    v_mfma_f32_16x16x32_bf16 v[80:83], v[208:211], v[252:255], v[80:83]
    ds_read2_b32 v[150:151], v39 offset0:194 offset1:195
    v_mfma_f32_16x16x32_bf16 v[84:87], v[208:211], v[248:251], v[84:87]
    v_mfma_f32_16x16x32_bf16 v[88:91], v[208:211], v[244:247], v[88:91]
    ds_read2_b32 v[152:153], v40 offset0:64 offset1:65
    v_mfma_f32_16x16x32_bf16 v[92:95], v[208:211], v[240:243], v[92:95]
    ds_read2_b32 v[154:155], v40 offset0:66 offset1:67
    buffer_load_dwordx4 v14, s[28:31], s81 offen offset:2048 lds
    v_mfma_f32_16x16x32_bf16 v[84:87], v[212:215], v[252:255], v[84:87]
    ds_read2_b32 v[156:157], v40 offset0:192 offset1:193
    v_mfma_f32_16x16x32_bf16 v[88:91], v[212:215], v[248:251], v[88:91]
    v_mfma_f32_16x16x32_bf16 v[92:95], v[212:215], v[244:247], v[92:95]
    ds_read2_b32 v[158:159], v40 offset0:194 offset1:195
    v_mfma_f32_16x16x32_bf16 v[88:91], v[216:219], v[252:255], v[88:91]
    buffer_load_dwordx4 v15, s[28:31], s81 offen offset:3072 lds
    s_waitcnt lgkmcnt(15)
    v_mfma_f32_16x16x32_bf16 v[92:95], v[216:219], v[248:251], v[92:95]
    v_mfma_f32_16x16x32_bf16 v[92:95], v[220:223], v[252:255], v[92:95]
    s_waitcnt lgkmcnt(0)
    v_mfma_f32_16x16x32_bf16 v[64:67], v[128:131], v[188:191], v[64:67]
    v_mfma_f32_16x16x32_bf16 v[68:71], v[128:131], v[184:187], v[68:71]
    ds_read2_b32 v[192:193], v37 offset0:96 offset1:97
    s_cmp_eq_u32 s83, 2
    s_cselect_b32 s96, s84, 0x8000
    s_add_u32 m0, s80, 32768
    s_add_u32 s81, s81, s96
    buffer_load_dwordx4 v12, s[28:31], s81 offen lds
    v_mfma_f32_16x16x32_bf16 v[72:75], v[128:131], v[180:183], v[72:75]
    ds_read2_b32 v[194:195], v37 offset0:98 offset1:99
    s_nop 1
    s_getreg_b32 s50, hwreg(HW_REG_IB_STS)
    s_and_b32 s50, s50, 0xc0000f
    s_or_b32 s50, s50, s87
    s_cmp_le_u32 s50, 0x400002
    s_cselect_b32 s50, 12582912, 0
    s_cselect_b32 s87, 0x80000000, s87
    buffer_store_dword v28, v3, s[48:51], s21 offen sc1
    v_mfma_f32_16x16x32_bf16 v[76:79], v[128:131], v[176:179], v[76:79]
    v_mfma_f32_16x16x32_bf16 v[80:83], v[128:131], v[172:175], v[80:83]
    ds_read_b128 v[252:255], v41 offset:3968
    v_mfma_f32_16x16x32_bf16 v[84:87], v[128:131], v[168:171], v[84:87]
    ds_read_b128 v[248:251], v41 offset:3456
    buffer_load_dwordx4 v13, s[28:31], s81 offen offset:1024 lds
    v_mfma_f32_16x16x32_bf16 v[88:91], v[128:131], v[164:167], v[88:91]
    ds_read_b128 v[244:247], v41 offset:2944
    v_mfma_f32_16x16x32_bf16 v[92:95], v[128:131], v[160:163], v[92:95]
    v_mfma_f32_16x16x32_bf16 v[68:71], v[132:135], v[188:191], v[68:71]
    ds_read_b128 v[240:243], v41 offset:2432
    v_mfma_f32_16x16x32_bf16 v[72:75], v[132:135], v[184:187], v[72:75]
    ds_read_b128 v[236:239], v41 offset:1920
    buffer_load_dwordx4 v14, s[28:31], s81 offen offset:2048 lds
    v_mfma_f32_16x16x32_bf16 v[76:79], v[132:135], v[180:183], v[76:79]
    ds_read_b128 v[232:235], v41 offset:1408
    v_mfma_f32_16x16x32_bf16 v[80:83], v[132:135], v[176:179], v[80:83]
    v_mfma_f32_16x16x32_bf16 v[84:87], v[132:135], v[172:175], v[84:87]
    ds_read_b128 v[228:231], v41 offset:896
    v_mfma_f32_16x16x32_bf16 v[88:91], v[132:135], v[168:171], v[88:91]
    ds_read_b128 v[224:227], v41 offset:384
    buffer_load_dwordx4 v15, s[28:31], s81 offen offset:3072 lds
    v_mfma_f32_16x16x32_bf16 v[92:95], v[132:135], v[164:167], v[92:95]
    ds_read2_b32 v[196:197], v37 offset0:224 offset1:225
    v_mfma_f32_16x16x32_bf16 v[72:75], v[136:139], v[188:191], v[72:75]
    v_mfma_f32_16x16x32_bf16 v[76:79], v[136:139], v[184:187], v[76:79]
    ds_read2_b32 v[198:199], v37 offset0:226 offset1:227
    v_mfma_f32_16x16x32_bf16 v[80:83], v[136:139], v[180:183], v[80:83]
    ds_read2_b32 v[200:201], v38 offset0:96 offset1:97
    s_add_u32 m0, s80, 36864
    s_add_u32 s81, s81, 32768
    buffer_load_dwordx4 v12, s[28:31], s81 offen lds
    v_mfma_f32_16x16x32_bf16 v[84:87], v[136:139], v[176:179], v[84:87]
    ds_read2_b32 v[202:203], v38 offset0:98 offset1:99
    v_mfma_f32_16x16x32_bf16 v[88:91], v[136:139], v[172:175], v[88:91]
    v_mfma_f32_16x16x32_bf16 v[92:95], v[136:139], v[168:171], v[92:95]
    ds_read2_b32 v[204:205], v38 offset0:224 offset1:225
    v_mfma_f32_16x16x32_bf16 v[76:79], v[140:143], v[188:191], v[76:79]
    ds_read2_b32 v[206:207], v38 offset0:226 offset1:227
    buffer_load_dwordx4 v13, s[28:31], s81 offen offset:1024 lds
    v_mfma_f32_16x16x32_bf16 v[80:83], v[140:143], v[184:187], v[80:83]
    ds_read2_b32 v[208:209], v39 offset0:96 offset1:97
    v_mfma_f32_16x16x32_bf16 v[84:87], v[140:143], v[180:183], v[84:87]
    v_mfma_f32_16x16x32_bf16 v[88:91], v[140:143], v[176:179], v[88:91]
    ds_read2_b32 v[210:211], v39 offset0:98 offset1:99
    v_mfma_f32_16x16x32_bf16 v[92:95], v[140:143], v[172:175], v[92:95]
    ds_read2_b32 v[212:213], v39 offset0:224 offset1:225
    buffer_load_dwordx4 v14, s[28:31], s81 offen offset:2048 lds
    v_mfma_f32_16x16x32_bf16 v[80:83], v[144:147], v[188:191], v[80:83]
    ds_read2_b32 v[214:215], v39 offset0:226 offset1:227
    v_mfma_f32_16x16x32_bf16 v[84:87], v[144:147], v[184:187], v[84:87]
    s_waitcnt vmcnt(25)
    s_cmp_eq_u32 s87, 0
    s_cselect_b32 s50, 12582912, 0
    s_mov_b32 s87, 0
    buffer_store_dword v28, v3, s[48:51], s21 offen sc1
    v_mfma_f32_16x16x32_bf16 v[88:91], v[144:147], v[180:183], v[88:91]
    ds_read2_b32 v[216:217], v40 offset0:96 offset1:97
    v_mfma_f32_16x16x32_bf16 v[92:95], v[144:147], v[176:179], v[92:95]
    ds_read2_b32 v[218:219], v40 offset0:98 offset1:99
    buffer_load_dwordx4 v15, s[28:31], s81 offen offset:3072 lds
    s_waitcnt vmcnt(19)
    v_mfma_f32_16x16x32_bf16 v[84:87], v[148:151], v[188:191], v[84:87]
    ds_read2_b32 v[220:221], v40 offset0:224 offset1:225
    v_mfma_f32_16x16x32_bf16 v[88:91], v[148:151], v[184:187], v[88:91]
    ds_read_b64_tr_b16 a[96:97], v35 offset:32768
    v_mfma_f32_16x16x32_bf16 v[92:95], v[148:151], v[180:183], v[92:95]
    ds_read2_b32 v[222:223], v40 offset0:226 offset1:227
    v_mfma_f32_16x16x32_bf16 v[88:91], v[152:155], v[188:191], v[88:91]
    s_cmp_eq_u32 s83, 1
    s_cselect_b32 s96, s84, 0x8000
    s_add_u32 m0, s80, 65536
    s_add_u32 s81, s81, s96
    buffer_load_dwordx4 v12, s[28:31], s81 offen lds
    v_mfma_f32_16x16x32_bf16 v[92:95], v[152:155], v[184:187], v[92:95]
    v_mfma_f32_16x16x32_bf16 v[92:95], v[156:159], v[188:191], v[92:95]
    s_waitcnt lgkmcnt(0)
    v_mfma_f32_16x16x32_bf16 v[64:67], v[192:195], v[252:255], v[64:67]
    ds_read_b64_tr_b16 a[98:99], v35 offset:33792
    v_mfma_f32_16x16x32_bf16 v[68:71], v[192:195], v[248:251], v[68:71]
    buffer_load_dwordx4 v13, s[28:31], s81 offen offset:1024 lds
    v_mfma_f32_16x16x32_bf16 v[72:75], v[192:195], v[244:247], v[72:75]
    ds_read_b64_tr_b16 a[100:101], v36 offset:32768
    v_mfma_f32_16x16x32_bf16 v[76:79], v[192:195], v[240:243], v[76:79]
    v_mfma_f32_16x16x32_bf16 v[80:83], v[192:195], v[236:239], v[80:83]
    ds_read_b64_tr_b16 a[102:103], v36 offset:33792
    v_mfma_f32_16x16x32_bf16 v[84:87], v[192:195], v[232:235], v[84:87]
    buffer_load_dwordx4 v14, s[28:31], s81 offen offset:2048 lds
    v_mfma_f32_16x16x32_bf16 v[88:91], v[192:195], v[228:231], v[88:91]
    ds_read_b64_tr_b16 a[104:105], v35 offset:34816
    v_mfma_f32_16x16x32_bf16 v[92:95], v[192:195], v[224:227], v[92:95]
    v_mfma_f32_16x16x32_bf16 v[68:71], v[196:199], v[252:255], v[68:71]
    ds_read_b64_tr_b16 a[106:107], v35 offset:35840
    v_mfma_f32_16x16x32_bf16 v[72:75], v[196:199], v[248:251], v[72:75]
    buffer_load_dwordx4 v15, s[28:31], s81 offen offset:3072 lds
    v_mfma_f32_16x16x32_bf16 v[76:79], v[196:199], v[244:247], v[76:79]
    v_mfma_f32_16x16x32_bf16 v[80:83], v[196:199], v[240:243], v[80:83]
    ds_read_b64_tr_b16 a[108:109], v36 offset:34816
    v_mfma_f32_16x16x32_bf16 v[84:87], v[196:199], v[236:239], v[84:87]
    v_mfma_f32_16x16x32_bf16 v[88:91], v[196:199], v[232:235], v[88:91]
    s_add_u32 m0, s80, 69632
    s_add_u32 s81, s81, 32768
    buffer_load_dwordx4 v12, s[28:31], s81 offen lds
    v_mfma_f32_16x16x32_bf16 v[92:95], v[196:199], v[228:231], v[92:95]
    ds_read_b64_tr_b16 a[110:111], v36 offset:35840
    v_mfma_f32_16x16x32_bf16 v[72:75], v[200:203], v[252:255], v[72:75]
    v_mfma_f32_16x16x32_bf16 v[76:79], v[200:203], v[248:251], v[76:79]
    ds_read_b64_tr_b16 a[112:113], v35 offset:36864
    v_mfma_f32_16x16x32_bf16 v[80:83], v[200:203], v[244:247], v[80:83]
    buffer_load_dwordx4 v13, s[28:31], s81 offen offset:1024 lds
    v_mfma_f32_16x16x32_bf16 v[84:87], v[200:203], v[240:243], v[84:87]
    s_load_dwordx4 s[8:11], s[36:37], s22 glc
    s_load_dwordx4 s[88:91], s[36:37], s22 offset:16 glc
    v_mfma_f32_16x16x32_bf16 v[88:91], v[200:203], v[236:239], v[88:91]
    ds_read_b64_tr_b16 a[114:115], v35 offset:37888
    v_mfma_f32_16x16x32_bf16 v[92:95], v[200:203], v[232:235], v[92:95]
    v_mfma_f32_16x16x32_bf16 v[76:79], v[204:207], v[252:255], v[76:79]
    buffer_load_dwordx4 v14, s[28:31], s81 offen offset:2048 lds
    v_mfma_f32_16x16x32_bf16 v[80:83], v[204:207], v[248:251], v[80:83]
    ds_read_b64_tr_b16 a[116:117], v36 offset:36864
    v_mfma_f32_16x16x32_bf16 v[84:87], v[204:207], v[244:247], v[84:87]
    ds_read_b64 v[112:113], v43 offset:1536
    v_mfma_f32_16x16x32_bf16 v[88:91], v[204:207], v[240:243], v[88:91]
    ds_read_b64_tr_b16 a[118:119], v36 offset:37888
    v_mfma_f32_16x16x32_bf16 v[92:95], v[204:207], v[236:239], v[92:95]
    buffer_load_dwordx4 v15, s[28:31], s81 offen offset:3072 lds
    v_mfma_f32_16x16x32_bf16 v[80:83], v[208:211], v[252:255], v[80:83]
    ds_read_b64_tr_b16 a[120:121], v35 offset:38912
    v_mfma_f32_16x16x32_bf16 v[84:87], v[208:211], v[248:251], v[84:87]
    ds_read_b64 v[114:115], v43 offset:1024
    v_mfma_f32_16x16x32_bf16 v[88:91], v[208:211], v[244:247], v[88:91]
    ds_read_b64_tr_b16 a[122:123], v35 offset:39936
    v_mfma_f32_16x16x32_bf16 v[92:95], v[208:211], v[240:243], v[92:95]
    ds_read_b64 v[116:117], v43 offset:512
    v_mfma_f32_16x16x32_bf16 v[84:87], v[212:215], v[252:255], v[84:87]
    ds_read_b64_tr_b16 a[124:125], v36 offset:38912
    v_mfma_f32_16x16x32_bf16 v[88:91], v[212:215], v[248:251], v[88:91]
    v_mfma_f32_16x16x32_bf16 v[92:95], v[212:215], v[244:247], v[92:95]
    ds_read_b64_tr_b16 a[126:127], v36 offset:39936
    ds_read_b64 v[118:119], v43 offset:0
    v_mfma_f32_16x16x32_bf16 v[88:91], v[216:219], v[252:255], v[88:91]
    v_mfma_f32_16x16x32_bf16 v[92:95], v[216:219], v[248:251], v[92:95]
    v_mov_b32 v120, s59
    v_mfma_f32_16x16x32_bf16 v[92:95], v[220:223], v[252:255], v[92:95]
    s_waitcnt lgkmcnt(1)
    v_and_b32 v96, 0xffff0000, v113
    v_lshlrev_b32 v97, 16, v113
    v_and_b32 v98, 0xffff0000, v112
    v_lshlrev_b32_e64 v99, 16, v112
    v_and_b32 v100, 0xffff0000, v115
    v_lshlrev_b32_e64 v101, 16, v115
    v_and_b32 v102, 0xffff0000, v114
    v_lshlrev_b32 v103, 16, v114
    s_cmp_eq_u32 s85, 0
    s_cbranch_scc0 L_odd
    ds_write_b128 v44, v[80:83] offset:0
    ds_write_b128 v44, v[84:87] offset:1024
    ds_write_b128 v44, v[88:91] offset:2048
    ds_write_b128 v44, v[92:95] offset:3072
    v_and_b32 v104, 0xffff0000, v117
    v_lshlrev_b32 v105, 16, v117
    v_and_b32 v106, 0xffff0000, v116
    v_lshlrev_b32 v107, 16, v116
    s_waitcnt lgkmcnt(4)
    v_and_b32 v108, 0xffff0000, v119
    v_lshlrev_b32_e64 v109, 16, v119
    v_and_b32 v110, 0xffff0000, v118
    v_lshlrev_b32_e64 v111, 16, v118
    v_pk_fma_f32 v[96:97], v[96:97], v[120:121], v[64:65] op_sel_hi:[1,0,1]
    v_pk_fma_f32 v[98:99], v[98:99], v[120:121], v[66:67] op_sel_hi:[1,0,1]
    v_pk_fma_f32 v[100:101], v[100:101], v[120:121], v[68:69] op_sel_hi:[1,0,1]
    v_pk_fma_f32 v[102:103], v[102:103], v[120:121], v[70:71] op_sel_hi:[1,0,1]
    v_pk_fma_f32 v[104:105], v[104:105], v[120:121], v[72:73] op_sel_hi:[1,0,1]
    v_pk_fma_f32 v[106:107], v[106:107], v[120:121], v[74:75] op_sel_hi:[1,0,1]
    v_pk_fma_f32 v[108:109], v[108:109], v[120:121], v[76:77] op_sel_hi:[1,0,1]
    v_pk_fma_f32 v[110:111], v[110:111], v[120:121], v[78:79] op_sel_hi:[1,0,1]
L_oddback:
    s_waitcnt lgkmcnt(0)
    s_barrier
    ds_read_b128 v[224:227], v45 offset:0
    ds_read_b128 v[228:231], v45 offset:1024
    ds_read_b128 v[232:235], v45 offset:2048
    ds_read_b128 v[236:239], v45 offset:3072
    s_add_u32 m0, s80, 131072
    s_add_u32 s6, s60, 15360
    buffer_load_dwordx4 v50, s[12:15], s60 offen lds
    buffer_load_dwordx4 v50, s[12:15], s6 offen offset:1024 lds
    buffer_load_dwordx2 v[8:9], v29, s[36:39], s61 offen sc1
    s_waitcnt lgkmcnt(3)
    v_pk_add_f32 v[96:97], v[96:97], v[224:225]
    v_pk_add_f32 v[98:99], v[98:99], v[226:227]
    v_cvt_pk_bf16_f32 v120, v96, v97
    v_cvt_pk_bf16_f32 v121, v98, v99
    s_waitcnt lgkmcnt(2)
    v_pk_add_f32 v[100:101], v[100:101], v[228:229]
    v_pk_add_f32 v[102:103], v[102:103], v[230:231]
    v_cvt_pk_bf16_f32 v122, v100, v101
    v_cvt_pk_bf16_f32 v123, v102, v103
    s_nop 0
    v_permlane16_swap_b32 v120, v122
    v_permlane16_swap_b32 v121, v123
    buffer_store_dwordx4 v[120:123], v46, s[36:39], s23 offen sc1
    s_waitcnt lgkmcnt(1)
    v_pk_add_f32 v[104:105], v[104:105], v[232:233]
    v_pk_add_f32 v[106:107], v[106:107], v[234:235]
    v_cvt_pk_bf16_f32 v124, v104, v105
    v_cvt_pk_bf16_f32 v125, v106, v107
    s_waitcnt lgkmcnt(0)
    v_pk_add_f32 v[108:109], v[108:109], v[236:237]
    v_pk_add_f32 v[110:111], v[110:111], v[238:239]
    v_cvt_pk_bf16_f32 v126, v108, v109
    v_cvt_pk_bf16_f32 v127, v110, v111
    s_nop 0
    v_permlane16_swap_b32 v124, v126
    v_permlane16_swap_b32 v125, v127
    buffer_store_dwordx4 v[124:127], v46, s[36:39], s23 offen offset:1024 sc1
    s_mov_b32 s91, s90
    s_xor_b64 s[8:9], s[8:9], s[56:57]
    s_xor_b64 s[10:11], s[10:11], s[56:57]
    s_or_b64 s[8:9], s[8:9], s[10:11]
    s_xor_b64 s[88:89], s[88:89], s[56:57]
    s_or_b64 s[8:9], s[8:9], s[88:89]
    s_xor_b64 s[90:91], s[90:91], s[56:57]
    s_or_b64 s[8:9], s[8:9], s[90:91]
    s_cbranch_scc1 L_rare1
L_back1:
    buffer_load_dwordx4 v[128:131], v2, s[36:39], s54 offen sc1
    s_waitcnt vmcnt(3)
    v_cmp_ne_u32 vcc, s58, v9
    s_nop 1
    s_cbranch_vccnz L_rare3
L_back3:
    v_and_b32 v9, 0xffff0000, v8
    v_rcp_f32 v9, v9
    v_lshlrev_b32 v8, 16, v8
    v_mul_f32 v10, v9, v9
    buffer_load_dwordx4 v[132:135], v2, s[36:39], s54 offen offset:1024 sc1
    v_mul_f32 v9, 0xbfb8aa3b, v9
    ds_read_b64 v[16:17], v53
    v_xor_b32_e64 v11, 16, v53
    ds_read_b64 v[18:19], v11
    buffer_load_dwordx4 v[136:139], v2, s[36:39], s54 offen offset:2048 sc1
    v_xor_b32_e64 v11, 32, v53
    ds_read_b64 v[20:21], v11
    v_xor_b32_e64 v11, 48, v53
    ds_read_b64 v[22:23], v11
    s_waitcnt lgkmcnt(3)
    v_lshlrev_b32 v224, 16, v16
    buffer_load_dwordx4 v[140:143], v2, s[36:39], s54 offen offset:3072 sc1
    s_cmp_eq_u32 s83, 6
    s_cselect_b32 s96, s92, 4096
    s_add_u32 s54, s54, s96
    v_and_b32 v225, 0xffff0000, v16
    v_lshlrev_b32_e64 v226, 16, v17
    v_and_b32 v227, 0xffff0000, v17
    s_waitcnt lgkmcnt(2)
    v_lshlrev_b32 v228, 16, v18
    v_and_b32 v229, 0xffff0000, v18
    buffer_load_dwordx4 v[144:147], v2, s[36:39], s54 offen sc1
    v_lshlrev_b32_e64 v230, 16, v19
    v_and_b32 v231, 0xffff0000, v19
    s_waitcnt lgkmcnt(1)
    v_lshlrev_b32 v232, 16, v20
    v_and_b32 v233, 0xffff0000, v20
    v_lshlrev_b32_e64 v234, 16, v21
    buffer_load_dwordx4 v[148:151], v2, s[36:39], s54 offen offset:1024 sc1
    v_and_b32 v235, 0xffff0000, v21
    s_waitcnt lgkmcnt(0)
    v_lshlrev_b32 v236, 16, v22
    v_and_b32 v237, 0xffff0000, v22
    v_lshlrev_b32_e64 v238, 16, v23
    v_and_b32 v239, 0xffff0000, v23
    buffer_load_dwordx4 v[152:155], v2, s[36:39], s54 offen offset:2048 sc1
    v_sub_f32 v240, v224, v8
    v_sub_f32 v241, v225, v8
    v_sub_f32 v242, v226, v8
    v_sub_f32 v243, v227, v8
    v_sub_f32_e64 v244, v228, v8
    buffer_load_dwordx4 v[156:159], v2, s[36:39], s54 offen offset:3072 sc1
    s_cmp_eq_u32 s83, 5
    s_cselect_b32 s96, s92, 4096
    s_add_u32 s54, s54, s96
    v_sub_f32 v245, v229, v8
    v_sub_f32 v246, v230, v8
    v_sub_f32 v247, v231, v8
    v_sub_f32 v248, v232, v8
    v_sub_f32_e64 v249, v233, v8
    buffer_load_dwordx4 v[160:163], v2, s[36:39], s54 offen sc1
    v_sub_f32 v250, v234, v8
    v_sub_f32 v251, v235, v8
    v_sub_f32 v252, v236, v8
    v_sub_f32 v253, v237, v8
    v_sub_f32_e64 v254, v238, v8
    buffer_load_dwordx4 v[164:167], v2, s[36:39], s54 offen offset:1024 sc1
    v_sub_f32 v255, v239, v8
    v_mul_f32 v240, v240, v10
    v_mul_f32 v241, v241, v10
    v_mul_f32 v242, v242, v10
    v_mul_f32_e64 v243, v243, v10
    buffer_load_dwordx4 v[168:171], v2, s[36:39], s54 offen offset:2048 sc1
    v_mul_f32 v244, v244, v10
    v_mul_f32 v245, v245, v10
    v_mul_f32 v246, v246, v10
    v_mul_f32 v247, v247, v10
    v_mul_f32_e64 v248, v248, v10
    buffer_load_dwordx4 v[172:175], v2, s[36:39], s54 offen offset:3072 sc1
    s_cmp_eq_u32 s83, 4
    s_cselect_b32 s96, s92, 4096
    s_add_u32 s54, s54, s96
    v_mul_f32 v249, v249, v10
    v_mul_f32 v250, v250, v10
    v_mul_f32 v251, v251, v10
    v_mul_f32 v252, v252, v10
    v_mul_f32 v253, v253, v10
    v_mul_f32 v254, v254, v10
    v_mul_f32 v255, v255, v10
    s_waitcnt vmcnt(11)
    v_mfma_f32_32x32x16_bf16 v[96:111], a[0:3], v[128:131], 0
    v_mfma_f32_32x32x16_bf16 v[112:127], a[4:7], v[128:131], 0
    buffer_load_dwordx4 v[128:131], v2, s[36:39], s54 offen sc1
    s_waitcnt vmcnt(11)
    v_mfma_f32_32x32x16_bf16 v[96:111], a[8:11], v[132:135], v[96:111]
    v_mfma_f32_32x32x16_bf16 v[112:127], a[12:15], v[132:135], v[112:127]
    buffer_load_dwordx4 v[132:135], v2, s[36:39], s54 offen offset:1024 sc1
    s_waitcnt vmcnt(11)
    v_mfma_f32_32x32x16_bf16 v[96:111], a[16:19], v[136:139], v[96:111]
    ds_read_b64_tr_b16 a[128:129], v33 offset:0
    ds_read_b64_tr_b16 a[130:131], v33 offset:1024
    v_mfma_f32_32x32x16_bf16 v[112:127], a[20:23], v[136:139], v[112:127]
    buffer_load_dwordx4 v[136:139], v2, s[36:39], s54 offen offset:2048 sc1
    ds_read_b64_tr_b16 a[132:133], v34 offset:0
    ds_read_b64_tr_b16 a[134:135], v34 offset:1024
    s_waitcnt vmcnt(11)
    v_mfma_f32_32x32x16_bf16 v[96:111], a[24:27], v[140:143], v[96:111]
    s_cmp_eq_u32 s87, 0
    s_cselect_b32 s50, 12582912, 0
    s_mov_b32 s87, 0
    buffer_store_dword v28, v3, s[48:51], s52 offen sc1
    ds_read_b64_tr_b16 a[136:137], v33 offset:2048
    v_mfma_f32_32x32x16_bf16 v[112:127], a[28:31], v[140:143], v[112:127]
    buffer_load_dwordx4 v[140:143], v2, s[36:39], s54 offen offset:3072 sc1
    s_cmp_eq_u32 s83, 3
    s_cselect_b32 s96, s92, 4096
    s_add_u32 s54, s54, s96
    s_waitcnt vmcnt(12)
    v_mfma_f32_32x32x16_bf16 v[96:111], a[32:35], v[144:147], v[96:111]
    ds_read_b64_tr_b16 a[138:139], v33 offset:3072
    ds_read_b64_tr_b16 a[140:141], v34 offset:2048
    v_mfma_f32_32x32x16_bf16 v[112:127], a[36:39], v[144:147], v[112:127]
    buffer_load_dwordx4 v[144:147], v2, s[36:39], s54 offen sc1
    ds_read_b64_tr_b16 a[142:143], v34 offset:3072
    ds_read_b64_tr_b16 a[144:145], v33 offset:4096
    s_waitcnt vmcnt(12)
    v_mfma_f32_32x32x16_bf16 v[96:111], a[40:43], v[148:151], v[96:111]
    ds_read_b64_tr_b16 a[146:147], v33 offset:5120
    ds_read_b64_tr_b16 a[148:149], v34 offset:4096
    ds_read_b64_tr_b16 a[150:151], v34 offset:5120
    v_mfma_f32_32x32x16_bf16 v[112:127], a[44:47], v[148:151], v[112:127]
    buffer_load_dwordx4 v[148:151], v2, s[36:39], s54 offen offset:1024 sc1
    ds_read_b64_tr_b16 a[152:153], v33 offset:6144
    s_waitcnt vmcnt(12)
    v_mfma_f32_32x32x16_bf16 v[96:111], a[48:51], v[152:155], v[96:111]
    ds_read_b64_tr_b16 a[154:155], v33 offset:7168
    ds_read_b64_tr_b16 a[156:157], v34 offset:6144
    ds_read_b64_tr_b16 a[158:159], v34 offset:7168
    v_mfma_f32_32x32x16_bf16 v[112:127], a[52:55], v[152:155], v[112:127]
    buffer_load_dwordx4 v[152:155], v2, s[36:39], s54 offen offset:2048 sc1
    ds_read_b64_tr_b16 a[160:161], v33 offset:32768
    ds_read_b64_tr_b16 a[162:163], v33 offset:33792
    s_waitcnt vmcnt(12)
    v_mfma_f32_32x32x16_bf16 v[96:111], a[56:59], v[156:159], v[96:111]
    ds_read_b64_tr_b16 a[164:165], v34 offset:32768
    ds_read_b64_tr_b16 a[166:167], v34 offset:33792
    v_mfma_f32_32x32x16_bf16 v[112:127], a[60:63], v[156:159], v[112:127]
    buffer_load_dwordx4 v[156:159], v2, s[36:39], s54 offen offset:3072 sc1
    s_cmp_eq_u32 s83, 2
    s_cselect_b32 s96, s92, 4096
    s_add_u32 s54, s54, s96
    s_waitcnt vmcnt(12)
    v_mfma_f32_32x32x16_bf16 v[96:111], a[64:67], v[160:163], v[96:111]
    ds_read_b64_tr_b16 a[168:169], v33 offset:34816
    ds_read_b64_tr_b16 a[170:171], v33 offset:35840
    ds_read_b64_tr_b16 a[172:173], v34 offset:34816
    v_mfma_f32_32x32x16_bf16 v[112:127], a[68:71], v[160:163], v[112:127]
    buffer_load_dwordx4 v[160:163], v2, s[36:39], s54 offen sc1
    ds_read_b64_tr_b16 a[174:175], v34 offset:35840
    s_waitcnt vmcnt(12)
    v_mfma_f32_32x32x16_bf16 v[96:111], a[72:75], v[164:167], v[96:111]
    ds_read_b64_tr_b16 a[176:177], v33 offset:36864
    ds_read_b64_tr_b16 a[178:179], v33 offset:37888
    ds_read_b64_tr_b16 a[180:181], v34 offset:36864
    v_mfma_f32_32x32x16_bf16 v[112:127], a[76:79], v[164:167], v[112:127]
    buffer_load_dwordx4 v[164:167], v2, s[36:39], s54 offen offset:1024 sc1
    ds_read_b64_tr_b16 a[182:183], v34 offset:37888
    ds_read_b64_tr_b16 a[184:185], v33 offset:38912
    s_waitcnt vmcnt(12)
    v_mfma_f32_32x32x16_bf16 v[96:111], a[80:83], v[168:171], v[96:111]
    ds_read_b64_tr_b16 a[186:187], v33 offset:39936
    ds_read_b64_tr_b16 a[188:189], v34 offset:38912
    v_mfma_f32_32x32x16_bf16 v[112:127], a[84:87], v[168:171], v[112:127]
    buffer_load_dwordx4 v[168:171], v2, s[36:39], s54 offen offset:2048 sc1
    ds_read_b64_tr_b16 a[190:191], v34 offset:39936
    ds_read_b64_tr_b16 a[192:193], v35 offset:0
    s_waitcnt vmcnt(12)
    v_mfma_f32_32x32x16_bf16 v[96:111], a[88:91], v[172:175], v[96:111]
    ds_read_b64_tr_b16 a[194:195], v35 offset:1024
    ds_read_b64_tr_b16 a[196:197], v36 offset:0
    v_mfma_f32_32x32x16_bf16 v[112:127], a[92:95], v[172:175], v[112:127]
    buffer_load_dwordx4 v[172:175], v2, s[36:39], s54 offen offset:3072 sc1
    s_cmp_eq_u32 s83, 1
    s_cselect_b32 s96, s92, 4096
    s_add_u32 s54, s54, s96
    ds_read_b64_tr_b16 a[198:199], v36 offset:1024
    s_waitcnt vmcnt(12)
    v_mfma_f32_32x32x16_bf16 v[96:111], a[96:99], v[128:131], v[96:111]
    ds_read_b64_tr_b16 a[200:201], v35 offset:2048
    ds_read_b64_tr_b16 a[202:203], v35 offset:3072
    v_mfma_f32_32x32x16_bf16 v[112:127], a[100:103], v[128:131], v[112:127]
    buffer_load_dwordx4 v[128:131], v2, s[36:39], s54 offen sc1
    ds_read_b64_tr_b16 a[204:205], v36 offset:2048
    ds_read_b64_tr_b16 a[206:207], v36 offset:3072
    s_waitcnt vmcnt(12)
    v_mfma_f32_32x32x16_bf16 v[96:111], a[104:107], v[132:135], v[96:111]
    ds_read_b64_tr_b16 a[208:209], v35 offset:4096
    ds_read_b64_tr_b16 a[210:211], v35 offset:5120
    v_mfma_f32_32x32x16_bf16 v[112:127], a[108:111], v[132:135], v[112:127]
    buffer_load_dwordx4 v[132:135], v2, s[36:39], s54 offen offset:1024 sc1
    ds_read_b64_tr_b16 a[212:213], v36 offset:4096
    ds_read_b64_tr_b16 a[214:215], v36 offset:5120
    s_waitcnt vmcnt(12)
    v_mfma_f32_32x32x16_bf16 v[96:111], a[112:115], v[136:139], v[96:111]
    ds_read_b64_tr_b16 a[216:217], v35 offset:6144
    ds_read_b64_tr_b16 a[218:219], v35 offset:7168
    v_mfma_f32_32x32x16_bf16 v[112:127], a[116:119], v[136:139], v[112:127]
    buffer_load_dwordx4 v[136:139], v2, s[36:39], s54 offen offset:2048 sc1
    ds_read_b64_tr_b16 a[220:221], v36 offset:6144
    ds_read_b64_tr_b16 a[222:223], v36 offset:7168
    s_waitcnt vmcnt(11)
    v_mfma_f32_32x32x16_bf16 v[96:111], a[120:123], v[140:143], v[96:111]
    v_mfma_f32_32x32x16_bf16 v[112:127], a[124:127], v[140:143], v[112:127]
    buffer_load_dwordx4 v[140:143], v2, s[36:39], s54 offen offset:3072 sc1
    s_waitcnt vmcnt(11) lgkmcnt(15)
    v_mfma_f32_32x32x16_bf16 v[96:111], a[128:131], v[144:147], v[96:111]
    v_mfma_f32_32x32x16_bf16 v[112:127], a[132:135], v[144:147], v[112:127]
    buffer_load_dwordx4 v[144:147], v2, s[36:39], s63 offen sc1
    s_waitcnt vmcnt(11)
    v_mfma_f32_32x32x16_bf16 v[96:111], a[136:139], v[148:151], v[96:111]
    v_mfma_f32_32x32x16_bf16 v[112:127], a[140:143], v[148:151], v[112:127]
    buffer_load_dwordx4 v[148:151], v2, s[36:39], s63 offen offset:1024 sc1
    s_waitcnt vmcnt(11)
    v_mfma_f32_32x32x16_bf16 v[96:111], a[144:147], v[152:155], v[96:111]
    v_mfma_f32_32x32x16_bf16 v[112:127], a[148:151], v[152:155], v[112:127]
    buffer_load_dwordx4 v[152:155], v2, s[36:39], s63 offen offset:2048 sc1
    s_waitcnt vmcnt(11)
    v_mfma_f32_32x32x16_bf16 v[96:111], a[152:155], v[156:159], v[96:111]
    v_mfma_f32_32x32x16_bf16 v[112:127], a[156:159], v[156:159], v[112:127]
    buffer_load_dwordx4 v[156:159], v2, s[36:39], s63 offen offset:3072 sc1
    s_cmp_eq_u32 s83, 6
    s_cselect_b32 s96, s92, 4096
    s_add_u32 s63, s63, s96
    s_waitcnt vmcnt(11)
    v_mfma_f32_32x32x16_bf16 v[96:111], a[160:163], v[160:163], v[96:111]
    v_mfma_f32_32x32x16_bf16 v[112:127], a[164:167], v[160:163], v[112:127]
    buffer_load_dwordx4 v[160:163], v2, s[36:39], s63 offen sc1
    s_waitcnt vmcnt(11)
    v_mfma_f32_32x32x16_bf16 v[96:111], a[168:171], v[164:167], v[96:111]
    v_mfma_f32_32x32x16_bf16 v[112:127], a[172:175], v[164:167], v[112:127]
    buffer_load_dwordx4 v[164:167], v2, s[36:39], s63 offen offset:1024 sc1
    s_waitcnt vmcnt(11)
    v_mfma_f32_32x32x16_bf16 v[96:111], a[176:179], v[168:171], v[96:111]
    v_mfma_f32_32x32x16_bf16 v[112:127], a[180:183], v[168:171], v[112:127]
    buffer_load_dwordx4 v[168:171], v2, s[36:39], s63 offen offset:2048 sc1
    s_waitcnt vmcnt(11)
    v_mfma_f32_32x32x16_bf16 v[96:111], a[184:187], v[172:175], v[96:111]
    v_mfma_f32_32x32x16_bf16 v[112:127], a[188:191], v[172:175], v[112:127]
    buffer_load_dwordx4 v[172:175], v2, s[36:39], s63 offen offset:3072 sc1
    s_cmp_eq_u32 s83, 5
    s_cselect_b32 s96, s92, 4096
    s_add_u32 s63, s63, s96
    s_waitcnt vmcnt(11) lgkmcnt(14)
    v_mfma_f32_32x32x16_bf16 v[96:111], a[192:195], v[128:131], v[96:111]
    s_waitcnt lgkmcnt(12)
    v_mfma_f32_32x32x16_bf16 v[112:127], a[196:199], v[128:131], v[112:127]
    buffer_load_dwordx4 v[128:131], v2, s[36:39], s63 offen sc1
    s_waitcnt vmcnt(11) lgkmcnt(10)
    v_mfma_f32_32x32x16_bf16 v[96:111], a[200:203], v[132:135], v[96:111]
    s_waitcnt lgkmcnt(8)
    v_mfma_f32_32x32x16_bf16 v[112:127], a[204:207], v[132:135], v[112:127]
    buffer_load_dwordx4 v[132:135], v2, s[36:39], s63 offen offset:1024 sc1
    s_waitcnt vmcnt(11) lgkmcnt(6)
    v_mfma_f32_32x32x16_bf16 v[96:111], a[208:211], v[136:139], v[96:111]
    s_waitcnt lgkmcnt(4)
    v_mfma_f32_32x32x16_bf16 v[112:127], a[212:215], v[136:139], v[112:127]
    buffer_load_dwordx4 v[136:139], v2, s[36:39], s63 offen offset:2048 sc1
    s_waitcnt vmcnt(11) lgkmcnt(2)
    v_mfma_f32_32x32x16_bf16 v[96:111], a[216:219], v[140:143], v[96:111]
    s_waitcnt lgkmcnt(0)
    v_mfma_f32_32x32x16_bf16 v[112:127], a[220:223], v[140:143], v[112:127]
    buffer_load_dwordx4 v[140:143], v2, s[36:39], s63 offen offset:3072 sc1
    s_cmp_eq_u32 s83, 4
    s_cselect_b32 s96, s92, 4096
    s_add_u32 s63, s63, s96
    s_waitcnt vmcnt(11)
    v_mfma_f32_32x32x16_bf16 v[64:79], a[0:3], v[144:147], 0
    v_mfma_f32_32x32x16_bf16 v[80:95], a[4:7], v[144:147], 0
    buffer_load_dwordx4 v[144:147], v2, s[36:39], s63 offen sc1
    s_waitcnt vmcnt(11)
    v_mfma_f32_32x32x16_bf16 v[64:79], a[8:11], v[148:151], v[64:79]
    v_mfma_f32_32x32x16_bf16 v[80:95], a[12:15], v[148:151], v[80:95]
    buffer_load_dwordx4 v[148:151], v2, s[36:39], s63 offen offset:1024 sc1
    ds_write_b128 v58, v[96:99] offset:0
    s_waitcnt vmcnt(11)
    v_mfma_f32_32x32x16_bf16 v[64:79], a[16:19], v[152:155], v[64:79]
    v_mfma_f32_32x32x16_bf16 v[80:95], a[20:23], v[152:155], v[80:95]
    buffer_load_dwordx4 v[152:155], v2, s[36:39], s63 offen offset:2048 sc1
    ds_write_b128 v58, v[100:103] offset:1024
    s_waitcnt vmcnt(11)
    v_mfma_f32_32x32x16_bf16 v[64:79], a[24:27], v[156:159], v[64:79]
    v_mfma_f32_32x32x16_bf16 v[80:95], a[28:31], v[156:159], v[80:95]
    buffer_load_dwordx4 v[156:159], v2, s[36:39], s63 offen offset:3072 sc1
    s_cmp_eq_u32 s83, 3
    s_cselect_b32 s96, s92, 4096
    s_add_u32 s63, s63, s96
    s_waitcnt vmcnt(11)
    v_mfma_f32_32x32x16_bf16 v[64:79], a[32:35], v[160:163], v[64:79]
    ds_write_b128 v58, v[104:107] offset:2048
    v_mfma_f32_32x32x16_bf16 v[80:95], a[36:39], v[160:163], v[80:95]
    buffer_load_dwordx4 v[160:163], v2, s[36:39], s63 offen sc1
    s_waitcnt vmcnt(11)
    v_mfma_f32_32x32x16_bf16 v[64:79], a[40:43], v[164:167], v[64:79]
    ds_write_b128 v58, v[108:111] offset:3072
    v_mfma_f32_32x32x16_bf16 v[80:95], a[44:47], v[164:167], v[80:95]
    buffer_load_dwordx4 v[164:167], v2, s[36:39], s63 offen offset:1024 sc1
    s_waitcnt vmcnt(11)
    v_mfma_f32_32x32x16_bf16 v[64:79], a[48:51], v[168:171], v[64:79]
    v_mfma_f32_32x32x16_bf16 v[80:95], a[52:55], v[168:171], v[80:95]
    buffer_load_dwordx4 v[168:171], v2, s[36:39], s63 offen offset:2048 sc1
    ds_write_b128 v58, v[112:115] offset:4096
    s_waitcnt vmcnt(11)
    v_mfma_f32_32x32x16_bf16 v[64:79], a[56:59], v[172:175], v[64:79]
    v_mfma_f32_32x32x16_bf16 v[80:95], a[60:63], v[172:175], v[80:95]
    buffer_load_dwordx4 v[172:175], v2, s[36:39], s63 offen offset:3072 sc1
    s_cmp_eq_u32 s83, 2
    s_cselect_b32 s96, s92, 4096
    s_add_u32 s63, s63, s96
    s_waitcnt vmcnt(11)
    v_mfma_f32_32x32x16_bf16 v[64:79], a[64:67], v[128:131], v[64:79]
    ds_write_b128 v58, v[116:119] offset:5120
    v_mfma_f32_32x32x16_bf16 v[80:95], a[68:71], v[128:131], v[80:95]
    buffer_load_dwordx4 v[128:131], v2, s[36:39], s63 offen sc1
    s_waitcnt vmcnt(11)
    v_mfma_f32_32x32x16_bf16 v[64:79], a[72:75], v[132:135], v[64:79]
    ds_write_b128 v58, v[120:123] offset:6144
    v_mfma_f32_32x32x16_bf16 v[80:95], a[76:79], v[132:135], v[80:95]
    buffer_load_dwordx4 v[132:135], v2, s[36:39], s63 offen offset:1024 sc1
    s_waitcnt vmcnt(11)
    v_mfma_f32_32x32x16_bf16 v[64:79], a[80:83], v[136:139], v[64:79]
    ds_write_b128 v58, v[124:127] offset:7168
    v_mfma_f32_32x32x16_bf16 v[80:95], a[84:87], v[136:139], v[80:95]
    buffer_load_dwordx4 v[136:139], v2, s[36:39], s63 offen offset:2048 sc1
    s_waitcnt vmcnt(11)
    v_mfma_f32_32x32x16_bf16 v[64:79], a[88:91], v[140:143], v[64:79]
    v_mfma_f32_32x32x16_bf16 v[80:95], a[92:95], v[140:143], v[80:95]
    buffer_load_dwordx4 v[140:143], v2, s[36:39], s63 offen offset:3072 sc1
    s_cmp_eq_u32 s83, 1
    s_cselect_b32 s96, s92, 4096
    s_add_u32 s63, s63, s96
    s_waitcnt vmcnt(11)
    v_mfma_f32_32x32x16_bf16 v[64:79], a[96:99], v[144:147], v[64:79]
    s_waitcnt lgkmcnt(0)
    s_barrier
    v_mfma_f32_32x32x16_bf16 v[80:95], a[100:103], v[144:147], v[80:95]
    buffer_load_dwordx4 v[144:147], v2, s[36:39], s63 offen sc1
    s_waitcnt vmcnt(11)
    v_mfma_f32_32x32x16_bf16 v[64:79], a[104:107], v[148:151], v[64:79]
    ds_read_b128 v[96:99], v59 offset:0
    buffer_load_dword v5, v49, s[36:39], s53 offen sc1
    v_mfma_f32_32x32x16_bf16 v[80:95], a[108:111], v[148:151], v[80:95]
    buffer_load_dwordx4 v[148:151], v2, s[36:39], s63 offen offset:1024 sc1
    ds_read_b128 v[100:103], v59 offset:1024
    s_waitcnt vmcnt(12)
    v_mfma_f32_32x32x16_bf16 v[64:79], a[112:115], v[152:155], v[64:79]
    ds_read_b128 v[104:107], v59 offset:2048
    ds_read_b128 v[108:111], v59 offset:3072
    v_mfma_f32_32x32x16_bf16 v[80:95], a[116:119], v[152:155], v[80:95]
    buffer_load_dwordx4 v[152:155], v2, s[36:39], s63 offen offset:2048 sc1
    ds_read_b128 v[112:115], v60 offset:4096
    s_waitcnt vmcnt(12)
    v_mfma_f32_32x32x16_bf16 v[64:79], a[120:123], v[156:159], v[64:79]
    ds_read_b128 v[116:119], v60 offset:5120
    v_mfma_f32_32x32x16_bf16 v[80:95], a[124:127], v[156:159], v[80:95]
    buffer_load_dwordx4 v[156:159], v2, s[36:39], s63 offen offset:3072 sc1
    ds_read_b128 v[120:123], v60 offset:6144
    s_waitcnt vmcnt(12)
    v_mfma_f32_32x32x16_bf16 v[64:79], a[128:131], v[160:163], v[64:79]
    ds_read_b128 v[124:127], v60 offset:7168
    s_waitcnt lgkmcnt(3)
    v_add_f32 v96, v96, v112
    v_mfma_f32_32x32x16_bf16 v[80:95], a[132:135], v[160:163], v[80:95]
    v_add_f32 v97, v97, v113
    s_waitcnt vmcnt(11)
    v_mfma_f32_32x32x16_bf16 v[64:79], a[136:139], v[164:167], v[64:79]
    v_add_f32 v98, v98, v114
    v_add_f32 v99, v99, v115
    v_mfma_f32_32x32x16_bf16 v[80:95], a[140:143], v[164:167], v[80:95]
    s_waitcnt lgkmcnt(2)
    v_add_f32 v100, v100, v116
    s_waitcnt vmcnt(10)
    v_mfma_f32_32x32x16_bf16 v[64:79], a[144:147], v[168:171], v[64:79]
    v_add_f32 v101, v101, v117
    v_mfma_f32_32x32x16_bf16 v[80:95], a[148:151], v[168:171], v[80:95]
    v_add_f32 v102, v102, v118
    v_add_f32 v103, v103, v119
    s_waitcnt vmcnt(9)
    v_mfma_f32_32x32x16_bf16 v[64:79], a[152:155], v[172:175], v[64:79]
    s_waitcnt lgkmcnt(1)
    v_add_f32_e64 v104, v104, v120
    v_mfma_f32_32x32x16_bf16 v[80:95], a[156:159], v[172:175], v[80:95]
    v_add_f32 v105, v105, v121
    s_waitcnt vmcnt(8)
    v_mfma_f32_32x32x16_bf16 v[64:79], a[160:163], v[128:131], v[64:79]
    v_add_f32 v106, v106, v122
    v_add_f32 v107, v107, v123
    v_mfma_f32_32x32x16_bf16 v[80:95], a[164:167], v[128:131], v[80:95]
    s_waitcnt lgkmcnt(0)
    v_add_f32 v108, v108, v124
    s_waitcnt vmcnt(7)
    v_mfma_f32_32x32x16_bf16 v[64:79], a[168:171], v[132:135], v[64:79]
    v_add_f32 v109, v109, v125
    v_add_f32 v110, v110, v126
    s_waitcnt vmcnt(3)
    v_cmp_ne_u32 vcc, s58, v5
    s_nop 1
    s_or_b32 s41, vcc_lo, vcc_hi
    s_cselect_b32 s26, 0, 12582912
    v_mfma_f32_32x32x16_bf16 v[80:95], a[172:175], v[132:135], v[80:95]
    v_add_f32 v111, v111, v127
    s_add_u32 s6, s55, 65536
    buffer_load_dwordx4 v[192:195], v51, s[24:27], s55 offen sc1
    buffer_load_dwordx4 v[196:199], v51, s[24:27], s6 offen sc1
    v_mfma_f32_32x32x16_bf16 v[64:79], a[176:179], v[136:139], v[64:79]
    v_mfma_f32_32x32x16_bf16 v[80:95], a[180:183], v[136:139], v[80:95]
    v_mfma_f32_32x32x16_bf16 v[64:79], a[184:187], v[140:143], v[64:79]
    v_mfma_f32_32x32x16_bf16 v[80:95], a[188:191], v[140:143], v[80:95]
    v_mfma_f32_32x32x16_bf16 v[80:95], a[196:199], v[144:147], v[80:95]
    s_waitcnt vmcnt(4)
    v_mfma_f32_32x32x16_bf16 v[80:95], a[204:207], v[148:151], v[80:95]
    s_waitcnt vmcnt(3)
    v_mfma_f32_32x32x16_bf16 v[80:95], a[212:215], v[152:155], v[80:95]
    s_waitcnt vmcnt(2)
    v_mfma_f32_32x32x16_bf16 v[80:95], a[220:223], v[156:159], v[80:95]
    v_mfma_f32_32x32x16_bf16 v[64:79], a[192:195], v[144:147], v[64:79]
    v_mfma_f32_32x32x16_bf16 v[64:79], a[200:203], v[148:151], v[64:79]
    s_nop 9
    ds_write_b128 v58, v[80:83] offset:32768
    ds_write_b128 v58, v[84:87] offset:33792
    ds_write_b128 v58, v[88:91] offset:34816
    ds_write_b128 v58, v[92:95] offset:35840
    v_mfma_f32_32x32x16_bf16 v[64:79], a[208:211], v[152:155], v[64:79]
    v_mfma_f32_32x32x16_bf16 v[64:79], a[216:219], v[156:159], v[64:79]
    s_waitcnt lgkmcnt(0)
    s_barrier
    ds_read_b128 v[80:83], v61 offset:32768
    ds_read_b128 v[84:87], v61 offset:33792
    ds_read_b128 v[88:91], v61 offset:34816
    ds_read_b128 v[92:95], v61 offset:35840
    s_nop 5
    v_pk_add_f32 v[64:65], v[64:65], v[96:97]
    v_pk_add_f32 v[66:67], v[66:67], v[98:99]
    v_pk_add_f32 v[68:69], v[68:69], v[100:101]
    v_pk_add_f32 v[70:71], v[70:71], v[102:103]
    v_pk_add_f32 v[72:73], v[72:73], v[104:105]
    v_pk_add_f32 v[74:75], v[74:75], v[106:107]
    v_pk_add_f32 v[76:77], v[76:77], v[108:109]
    v_pk_add_f32 v[78:79], v[78:79], v[110:111]
    s_waitcnt lgkmcnt(3)
    v_pk_add_f32 v[64:65], v[64:65], v[80:81]
    v_pk_add_f32 v[66:67], v[66:67], v[82:83]
    s_waitcnt lgkmcnt(2)
    v_pk_add_f32 v[68:69], v[68:69], v[84:85]
    v_pk_add_f32 v[70:71], v[70:71], v[86:87]
    s_waitcnt lgkmcnt(1)
    v_pk_add_f32 v[72:73], v[72:73], v[88:89]
    v_pk_add_f32 v[74:75], v[74:75], v[90:91]
    s_waitcnt lgkmcnt(0)
    v_pk_add_f32 v[76:77], v[76:77], v[92:93]
    v_pk_add_f32 v[78:79], v[78:79], v[94:95]
    v_pk_mul_f32 v[128:129], v[64:65], v[8:9] op_sel:[0,1] op_sel_hi:[1,1]
    v_pk_mul_f32 v[130:131], v[66:67], v[8:9] op_sel:[0,1] op_sel_hi:[1,1]
    v_pk_mul_f32 v[132:133], v[68:69], v[8:9] op_sel:[0,1] op_sel_hi:[1,1]
    v_pk_mul_f32 v[134:135], v[70:71], v[8:9] op_sel:[0,1] op_sel_hi:[1,1]
    v_pk_mul_f32 v[136:137], v[72:73], v[8:9] op_sel:[0,1] op_sel_hi:[1,1]
    v_pk_mul_f32 v[138:139], v[74:75], v[8:9] op_sel:[0,1] op_sel_hi:[1,1]
    v_pk_mul_f32 v[140:141], v[76:77], v[8:9] op_sel:[0,1] op_sel_hi:[1,1]
    v_pk_mul_f32 v[142:143], v[78:79], v[8:9] op_sel:[0,1] op_sel_hi:[1,1]
    v_exp_f32_e64 v128, v128
    v_exp_f32_e64 v129, v129
    v_exp_f32_e64 v130, v130
    v_exp_f32_e64 v131, v131
    v_exp_f32_e64 v132, v132
    v_exp_f32_e64 v133, v133
    v_exp_f32_e64 v134, v134
    v_exp_f32_e64 v135, v135
    v_exp_f32_e64 v136, v136
    v_exp_f32_e64 v137, v137
    v_exp_f32_e64 v138, v138
    v_exp_f32_e64 v139, v139
    v_exp_f32_e64 v140, v140
    v_exp_f32_e64 v141, v141
    v_exp_f32_e64 v142, v142
    v_exp_f32_e64 v143, v143
    s_waitcnt vmcnt(1)
    ds_write_b128 v54, v[192:195]
    s_waitcnt vmcnt(0)
    ds_write_b128 v54, v[196:199] offset:1024
    ds_read_b64_tr_b16 v[16:17], v55 offset:0
    ds_read_b64_tr_b16 v[18:19], v55 offset:512
    ds_read_b64_tr_b16 v[20:21], v55 offset:1024
    ds_read_b64_tr_b16 v[22:23], v55 offset:1536
    v_pk_add_f32 v[128:129], v[128:129], 1.0 op_sel_hi:[1,0]
    v_pk_add_f32 v[130:131], v[130:131], 1.0 op_sel_hi:[1,0]
    v_pk_add_f32 v[132:133], v[132:133], 1.0 op_sel_hi:[1,0]
    v_pk_add_f32 v[134:135], v[134:135], 1.0 op_sel_hi:[1,0]
    v_pk_add_f32 v[136:137], v[136:137], 1.0 op_sel_hi:[1,0]
    v_pk_add_f32 v[138:139], v[138:139], 1.0 op_sel_hi:[1,0]
    v_pk_add_f32 v[140:141], v[140:141], 1.0 op_sel_hi:[1,0]
    v_pk_add_f32 v[142:143], v[142:143], 1.0 op_sel_hi:[1,0]
    v_rcp_f32_e64 v128, v128
    v_rcp_f32_e64 v129, v129
    v_rcp_f32_e64 v130, v130
    v_rcp_f32_e64 v131, v131
    v_rcp_f32_e64 v132, v132
    v_rcp_f32_e64 v133, v133
    v_rcp_f32_e64 v134, v134
    v_rcp_f32_e64 v135, v135
    v_rcp_f32_e64 v136, v136
    v_rcp_f32_e64 v137, v137
    v_rcp_f32_e64 v138, v138
    v_rcp_f32_e64 v139, v139
    v_rcp_f32_e64 v140, v140
    v_rcp_f32_e64 v141, v141
    v_rcp_f32_e64 v142, v142
    v_rcp_f32_e64 v143, v143
    v_pk_mul_f32 v[64:65], v[64:65], v[240:241]
    v_pk_mul_f32 v[66:67], v[66:67], v[242:243]
    v_pk_mul_f32 v[68:69], v[68:69], v[244:245]
    v_pk_mul_f32 v[70:71], v[70:71], v[246:247]
    v_pk_mul_f32 v[72:73], v[72:73], v[248:249]
    v_pk_mul_f32 v[74:75], v[74:75], v[250:251]
    v_pk_mul_f32 v[76:77], v[76:77], v[252:253]
    v_pk_mul_f32 v[78:79], v[78:79], v[254:255]
    v_pk_mul_f32 v[64:65], v[64:65], v[128:129]
    v_pk_mul_f32 v[66:67], v[66:67], v[130:131]
    v_pk_mul_f32 v[68:69], v[68:69], v[132:133]
    v_pk_mul_f32 v[70:71], v[70:71], v[134:135]
    v_pk_mul_f32 v[72:73], v[72:73], v[136:137]
    v_pk_mul_f32 v[74:75], v[74:75], v[138:139]
    v_pk_mul_f32 v[76:77], v[76:77], v[140:141]
    v_pk_mul_f32 v[78:79], v[78:79], v[142:143]
    s_cmp_lg_u32 s41, 0
    s_cbranch_scc1 L_rare4
L_back4:
    s_waitcnt lgkmcnt(3)
    v_lshlrev_b32_e64 v160, 16, v16
    v_and_b32 v161, 0xffff0000, v16
    v_lshlrev_b32_e64 v162, 16, v17
    v_and_b32 v163, 0xffff0000, v17
    v_pk_fma_f32 v[128:129], v[64:65], v[160:161], v[224:225]
    v_pk_fma_f32 v[130:131], v[66:67], v[162:163], v[226:227]
    v_cvt_pk_bf16_f32 v144, v128, v129
    v_cvt_pk_bf16_f32 v145, v130, v131
    ds_write_b64 v56, v[144:145] offset:0
    s_waitcnt lgkmcnt(3)
    v_lshlrev_b32 v164, 16, v18
    v_and_b32 v165, 0xffff0000, v18
    v_lshlrev_b32_e64 v166, 16, v19
    v_and_b32 v167, 0xffff0000, v19
    v_pk_fma_f32 v[132:133], v[68:69], v[164:165], v[228:229]
    v_pk_fma_f32 v[134:135], v[70:71], v[166:167], v[230:231]
    v_cvt_pk_bf16_f32 v146, v132, v133
    v_cvt_pk_bf16_f32 v147, v134, v135
    ds_write_b64 v56, v[146:147] offset:16
    s_waitcnt lgkmcnt(3)
    v_lshlrev_b32 v168, 16, v20
    v_and_b32 v169, 0xffff0000, v20
    v_lshlrev_b32_e64 v170, 16, v21
    v_and_b32 v171, 0xffff0000, v21
    v_pk_fma_f32 v[136:137], v[72:73], v[168:169], v[232:233]
    v_pk_fma_f32 v[138:139], v[74:75], v[170:171], v[234:235]
    v_cvt_pk_bf16_f32 v148, v136, v137
    v_cvt_pk_bf16_f32 v149, v138, v139
    ds_write_b64 v56, v[148:149] offset:32
    s_waitcnt lgkmcnt(3)
    v_lshlrev_b32 v172, 16, v22
    v_and_b32 v173, 0xffff0000, v22
    v_lshlrev_b32_e64 v174, 16, v23
    v_and_b32 v175, 0xffff0000, v23
    v_pk_fma_f32 v[140:141], v[76:77], v[172:173], v[236:237]
    v_pk_fma_f32 v[142:143], v[78:79], v[174:175], v[238:239]
    v_cvt_pk_bf16_f32 v150, v140, v141
    v_cvt_pk_bf16_f32 v151, v142, v143
    ds_write_b64 v56, v[150:151] offset:48
    s_add_u32 s6, s60, 16384
    ds_read_b128 v[128:131], v57
    ds_read_b128 v[132:135], v57 offset:1280
    s_waitcnt lgkmcnt(1)
    buffer_store_dwordx4 v[128:131], v52, s[44:47], s60 offen
    s_waitcnt lgkmcnt(0)
    buffer_store_dwordx4 v[132:135], v52, s[44:47], s6 offen
L_end:
    s_endpgm
L_spare1:
    s_lshl_b32 s64, s3, 2
    s_and_b32 s65, s4, 3
    s_add_u32 s64, s64, s65
    s_lshl_b32 s64, s64, 16
    s_lshl_b32 s66, s5, 13
    s_add_u32 s64, s64, s66
    s_add_u32 s64, s64, 384
    s_add_u32 s66, s64, 32768
    buffer_load_dwordx4 a[64:67], v237, s[16:19], s64 offen
    buffer_load_dwordx4 a[68:71], v237, s[20:23], s64 offen
    buffer_load_dwordx4 a[72:75], v237, s[16:19], s66 offen
    buffer_load_dwordx4 a[76:79], v237, s[20:23], s66 offen
    s_add_u32 m0, s43, 132112
    s_nop 0
    buffer_load_dwordx4 v237, s[16:19], s41 offen nt lds
    s_add_u32 m0, s43, 140432
    s_nop 0
    buffer_load_dwordx4 v237, s[20:23], s41 offen nt lds
    s_add_u32 m0, s43, 136272
    s_nop 0
    buffer_load_dwordx4 v237, s[16:19], s42 offen nt lds
    s_add_u32 m0, s43, 144592
    s_nop 0
    buffer_load_dwordx4 v237, s[20:23], s42 offen nt lds
    s_mov_b32 m0, 131072
    s_nop 0
    buffer_load_dwordx4 v239, s[60:63], s40 offen nt lds
    v_mov_b32_e64 v4, v237
    s_load_dword s58, s[48:49], 0
    s_lshl_b32 s21, s97, 1
    s_add_u32 s21, s21, s86
    s_lshl_b32 s21, s21, 5
    s_lshl_b32 s6, s98, 1
    s_add_u32 s6, s6, s85
    s_mul_i32 s7, s6, 37
    s_lshr_b32 s7, s7, 8
    s_lshr_b32 s21, s21, 3
    s_add_u32 s21, s21, s7
    s_lshl_b32 s21, s21, 7
    s_mul_i32 s7, s7, 7
    s_sub_u32 s6, s6, s7
    s_lshl_b32 s6, s6, 2
    s_add_u32 s21, s21, s6
    s_add_u32 s21, s21, 11730944
    s_lshl_b32 s6, s100, 2
    s_add_u32 s6, s6, s5
    s_lshl_b32 s16, s6, 16
    s_lshl_b32 s7, s99, 7
    s_sub_u32 s16, s16, s7
    s_add_u32 s16, s16, 7344000
    s_add_u32 s17, s16, 4096
    s_lshl_b32 s18, s6, 1
    s_lshr_b32 s7, s99, 4
    s_add_u32 s18, s18, s7
    s_lshl_b32 s18, s18, 7
    s_and_b32 s7, s99, 15
    s_lshl_b32 s7, s7, 2
    s_add_u32 s18, s18, s7
    s_add_u32 s18, s18, 11599872
    s_lshr_b32 s19, s101, 4
    s_lshl_b32 s19, s19, 8
    s_lshl_b32 s6, s85, 7
    s_sub_u32 s19, s19, s6
    s_add_u32 s19, s19, 11600000
    s_lshl_b32 s6, s85, 11
    s_lshl_b32 s62, s101, 12
    s_add_u32 s20, s62, s6
    s_add_u32 s23, s20, 9437184
    s_add_u32 s20, s20, 7340032
    s_lshl_b32 s6, s85, 1
    s_add_u32 s62, s62, s6
    s_lshl_b32 s22, s99, 2
    s_mul_i32 s42, s5, 1
    s_add_u32 s22, s22, s42
    s_lshl_b32 s22, s22, 7
    s_add_u32 s22, s22, 11730944
    s_lshr_b32 s52, s101, 5
    s_lshl_b32 s52, s52, 1
    s_add_u32 s52, s52, s85
    s_lshl_b32 s52, s52, 7
    s_and_b32 s42, s101, 31
    s_lshl_b32 s42, s42, 2
    s_add_u32 s52, s52, s42
    s_add_u32 s52, s52, 11862016
    s_lshl_b32 s42, s100, 1
    s_add_u32 s42, s42, s85
    s_lshl_b32 s53, s42, 8
    s_lshr_b32 s43, s99, 4
    s_lshl_b32 s43, s43, 7
    s_add_u32 s53, s53, s43
    s_add_u32 s53, s53, 11862016
    s_lshl_b32 s55, s42, 17
    s_lshl_b32 s60, s42, 6
    s_lshl_b32 s42, s99, 1
    s_add_u32 s42, s42, s86
    s_lshl_b32 s43, s42, 6
    s_add_u32 s55, s55, s43
    s_add_u32 s55, s55, 9437184
    s_lshl_b32 s43, s42, 15
    s_add_u32 s60, s60, s43
    s_lshl_b32 s61, s42, 9
    s_add_u32 s61, s61, 11534336
    s_mul_i32 s63, s42, 114688
    s_xor_b32 s42, s42, 1
    s_mul_i32 s54, s42, 114688
    s_mul_i32 s42, s5, 28672
    s_lshl_b32 s43, s83, 12
    s_add_u32 s42, s42, s43
    s_add_u32 s54, s54, s42
    s_add_u32 s63, s63, s42
    s_waitcnt lgkmcnt(0)
    s_cmp_eq_u32 s58, 0
    s_cbranch_scc1 L_rareM
L_backM:
    v_mov_b32 v28, s58
    v_mov_b32_e64 v197, v28
    buffer_store_dwordx2 v[196:197], v198, s[36:39], s84 offen sc1
    v_and_b32_e64 v252, 7, v1
    v_mul_u32_u24 v253, 1040, v252
    v_lshrrev_b32_e64 v254, 3, v1
    v_lshl_add_u32 v253, v254, 2, v253
    s_lshl_b32 s6, s5, 5
    s_add_u32 s6, s6, 131072
    v_add_u32 v253, s6, v253
    v_add_u32 v255, 1040, v253
    v_xor_b32 v252, 7, v252
    v_lshlrev_b32 v252, 4, v252
    v_lshl_add_u32 v252, v254, 13, v252
    v_add_u32 v254, 9360, v253
    s_mul_i32 s64, s65, 458752
    s_lshl_b32 s66, s5, 14
    s_add_u32 s70, s64, s66
    s_add_u32 s70, s70, 384
    s_mul_i32 s65, s3, 1
    s_add_u32 s71, s65, 3
    s_mul_i32 s69, s71, 37
    s_lshr_b32 s69, s69, 8
    s_mul_i32 s69, s69, 7
    s_sub_u32 s67, s71, s69
    s_lshl_b32 s67, s67, 16
    s_add_u32 s67, s67, s70
    s_add_u32 s68, s67, 8192
    s_add_u32 s71, s71, 1
    buffer_load_dwordx4 a[80:83], v4, s[28:31], s67 offen
    buffer_load_dwordx4 a[84:87], v4, s[28:31], s68 offen
    s_mul_i32 s69, s71, 37
    s_lshr_b32 s69, s69, 8
    s_mul_i32 s69, s69, 7
    s_sub_u32 s67, s71, s69
    s_lshl_b32 s67, s67, 16
    s_add_u32 s67, s67, s70
    s_add_u32 s68, s67, 8192
    s_add_u32 s71, s71, 1
    buffer_load_dwordx4 a[80:83], v4, s[28:31], s67 offen
    buffer_load_dwordx4 a[84:87], v4, s[28:31], s68 offen
    s_mul_i32 s69, s71, 37
    s_lshr_b32 s69, s69, 8
    s_mul_i32 s69, s69, 7
    s_sub_u32 s67, s71, s69
    s_lshl_b32 s67, s67, 16
    s_add_u32 s67, s67, s70
    s_add_u32 s68, s67, 8192
    s_add_u32 s71, s71, 1
    buffer_load_dwordx4 a[80:83], v4, s[28:31], s67 offen
    buffer_load_dwordx4 a[84:87], v4, s[28:31], s68 offen
    s_mul_i32 s69, s71, 37
    s_lshr_b32 s69, s69, 8
    s_mul_i32 s69, s69, 7
    s_sub_u32 s67, s71, s69
    s_lshl_b32 s67, s67, 16
    s_add_u32 s67, s67, s70
    s_add_u32 s68, s67, 8192
    s_add_u32 s71, s71, 1
    buffer_load_dwordx4 a[80:83], v4, s[28:31], s67 offen
    buffer_load_dwordx4 a[84:87], v4, s[28:31], s68 offen
    s_mul_i32 s69, s71, 37
    s_lshr_b32 s69, s69, 8
    s_mul_i32 s69, s69, 7
    s_sub_u32 s67, s71, s69
    s_lshl_b32 s67, s67, 16
    s_add_u32 s67, s67, s70
    s_add_u32 s68, s67, 8192
    s_add_u32 s71, s71, 1
    buffer_load_dwordx4 a[80:83], v4, s[28:31], s67 offen
    buffer_load_dwordx4 a[84:87], v4, s[28:31], s68 offen
    s_mul_i32 s69, s71, 37
    s_lshr_b32 s69, s69, 8
    s_mul_i32 s69, s69, 7
    s_sub_u32 s67, s71, s69
    s_lshl_b32 s67, s67, 16
    s_add_u32 s67, s67, s70
    s_add_u32 s68, s67, 8192
    s_add_u32 s71, s71, 1
    buffer_load_dwordx4 a[80:83], v4, s[28:31], s67 offen
    buffer_load_dwordx4 a[84:87], v4, s[28:31], s68 offen
    s_mul_i32 s69, s71, 37
    s_lshr_b32 s69, s69, 8
    s_mul_i32 s69, s69, 7
    s_sub_u32 s67, s71, s69
    s_lshl_b32 s67, s67, 16
    s_add_u32 s67, s67, s70
    s_add_u32 s68, s67, 8192
    s_add_u32 s71, s71, 1
    buffer_load_dwordx4 a[80:83], v4, s[28:31], s67 offen
    buffer_load_dwordx4 a[84:87], v4, s[28:31], s68 offen
    s_waitcnt vmcnt(15)
    s_barrier
    ds_read2_b32 v[232:233], v253 offset0:160 offset1:192
    ds_read_b32 v234, v253 offset:896
    ds_read2_b32 v[236:237], v255 offset0:0 offset1:32
    ds_read2_b32 v[238:239], v255 offset0:64 offset1:96
    ds_read2_b32 v[240:241], v255 offset0:128 offset1:160
    ds_read2_b32 v[242:243], v255 offset0:192 offset1:224
    ds_read2_b32 v[244:245], v254 offset0:0 offset1:32
    ds_read2_b32 v[246:247], v254 offset0:64 offset1:96
    ds_read2_b32 v[248:249], v254 offset0:128 offset1:160
    ds_read2_b32 v[250:251], v254 offset0:192 offset1:224
    v_lshlrev_b32 v220, 16, v228
    v_lshlrev_b32_e64 v221, 16, v230
    v_and_b32 v222, 0xffff0000, v228
    v_and_b32 v223, 0xffff0000, v230
    v_lshlrev_b32 v224, 16, v229
    v_lshlrev_b32 v225, 16, v231
    v_and_b32 v226, 0xffff0000, v229
    v_and_b32 v227, 0xffff0000, v231
    s_waitcnt lgkmcnt(9)
    v_lshlrev_b32 v176, 16, v232
    v_and_b32 v177, 0xffff0000, v232
    v_lshlrev_b32_e64 v178, 16, v233
    v_and_b32 v179, 0xffff0000, v233
    s_waitcnt lgkmcnt(8)
    v_lshlrev_b32 v180, 16, v234
    v_and_b32 v181, 0xffff0000, v234
    s_waitcnt lgkmcnt(7)
    v_lshlrev_b32 v184, 16, v236
    v_and_b32 v185, 0xffff0000, v236
    v_lshlrev_b32_e64 v186, 16, v237
    v_and_b32 v187, 0xffff0000, v237
    s_waitcnt lgkmcnt(6)
    v_lshlrev_b32 v188, 16, v238
    v_and_b32 v189, 0xffff0000, v238
    v_lshlrev_b32_e64 v190, 16, v239
    v_and_b32 v191, 0xffff0000, v239
    s_waitcnt lgkmcnt(5)
    v_lshlrev_b32 v192, 16, v240
    v_and_b32 v193, 0xffff0000, v240
    v_lshlrev_b32_e64 v194, 16, v241
    v_and_b32 v195, 0xffff0000, v241
    s_waitcnt lgkmcnt(4)
    v_lshlrev_b32 v196, 16, v242
    v_and_b32 v197, 0xffff0000, v242
    v_lshlrev_b32_e64 v198, 16, v243
    v_and_b32 v199, 0xffff0000, v243
    v_pk_mul_f32 v[200:201], v[184:185], v[220:221]
    v_pk_mul_f32 v[202:203], v[186:187], v[220:221]
    v_pk_mul_f32 v[204:205], v[188:189], v[220:221]
    v_pk_mul_f32 v[206:207], v[190:191], v[220:221]
    v_pk_mul_f32 v[208:209], v[192:193], v[220:221]
    v_pk_mul_f32 v[210:211], v[194:195], v[220:221]
    v_pk_mul_f32 v[212:213], v[196:197], v[220:221]
    v_pk_mul_f32 v[214:215], v[198:199], v[220:221]
    v_pk_fma_f32 v[200:201], v[180:181], v[222:223], v[200:201]
    v_pk_fma_f32 v[202:203], v[184:185], v[222:223], v[202:203]
    v_pk_fma_f32 v[204:205], v[186:187], v[222:223], v[204:205]
    v_pk_fma_f32 v[206:207], v[188:189], v[222:223], v[206:207]
    v_pk_fma_f32 v[208:209], v[190:191], v[222:223], v[208:209]
    v_pk_fma_f32 v[210:211], v[192:193], v[222:223], v[210:211]
    v_pk_fma_f32 v[212:213], v[194:195], v[222:223], v[212:213]
    v_pk_fma_f32 v[214:215], v[196:197], v[222:223], v[214:215]
    v_pk_fma_f32 v[200:201], v[178:179], v[224:225], v[200:201]
    v_pk_fma_f32 v[202:203], v[180:181], v[224:225], v[202:203]
    v_pk_fma_f32 v[204:205], v[184:185], v[224:225], v[204:205]
    v_pk_fma_f32 v[206:207], v[186:187], v[224:225], v[206:207]
    v_pk_fma_f32 v[208:209], v[188:189], v[224:225], v[208:209]
    v_pk_fma_f32 v[210:211], v[190:191], v[224:225], v[210:211]
    v_pk_fma_f32 v[212:213], v[192:193], v[224:225], v[212:213]
    v_pk_fma_f32 v[214:215], v[194:195], v[224:225], v[214:215]
    v_pk_fma_f32 v[200:201], v[176:177], v[226:227], v[200:201]
    v_pk_fma_f32 v[202:203], v[178:179], v[226:227], v[202:203]
    v_pk_fma_f32 v[204:205], v[180:181], v[226:227], v[204:205]
    v_pk_fma_f32 v[206:207], v[184:185], v[226:227], v[206:207]
    v_pk_fma_f32 v[208:209], v[186:187], v[226:227], v[208:209]
    v_pk_fma_f32 v[210:211], v[188:189], v[226:227], v[210:211]
    v_pk_fma_f32 v[212:213], v[190:191], v[226:227], v[212:213]
    v_pk_fma_f32 v[214:215], v[192:193], v[226:227], v[214:215]
    s_waitcnt lgkmcnt(3)
    v_lshlrev_b32 v176, 16, v244
    v_and_b32 v177, 0xffff0000, v244
    v_lshlrev_b32_e64 v178, 16, v245
    v_and_b32 v179, 0xffff0000, v245
    s_waitcnt lgkmcnt(2)
    v_lshlrev_b32 v180, 16, v246
    v_and_b32 v181, 0xffff0000, v246
    v_lshlrev_b32_e64 v182, 16, v247
    v_and_b32 v183, 0xffff0000, v247
    s_waitcnt lgkmcnt(1)
    v_lshlrev_b32 v184, 16, v248
    v_and_b32 v185, 0xffff0000, v248
    v_lshlrev_b32_e64 v186, 16, v249
    v_and_b32 v187, 0xffff0000, v249
    s_waitcnt lgkmcnt(0)
    v_lshlrev_b32 v188, 16, v250
    v_and_b32 v189, 0xffff0000, v250
    v_lshlrev_b32_e64 v190, 16, v251
    v_and_b32 v191, 0xffff0000, v251
    v_pk_mul_f32 v[200:201], v[200:201], v[176:177]
    v_pk_mul_f32 v[202:203], v[202:203], v[178:179]
    v_pk_mul_f32 v[204:205], v[204:205], v[180:181]
    v_pk_mul_f32 v[206:207], v[206:207], v[182:183]
    v_pk_mul_f32 v[208:209], v[208:209], v[184:185]
    v_pk_mul_f32 v[210:211], v[210:211], v[186:187]
    v_pk_mul_f32 v[212:213], v[212:213], v[188:189]
    v_pk_mul_f32 v[214:215], v[214:215], v[190:191]
    v_cvt_pk_bf16_f32 v232, v214, v212
    v_cvt_pk_bf16_f32 v233, v210, v208
    v_cvt_pk_bf16_f32 v234, v206, v204
    v_cvt_pk_bf16_f32 v235, v202, v200
    buffer_store_dwordx4 v[232:235], v252, s[36:39], s16 offen sc1
    v_cvt_pk_bf16_f32 v236, v215, v213
    v_cvt_pk_bf16_f32 v237, v211, v209
    v_cvt_pk_bf16_f32 v238, v207, v205
    v_cvt_pk_bf16_f32 v239, v203, v201
    buffer_store_dwordx4 v[236:239], v252, s[36:39], s17 offen sc1
    s_mov_b64 s[48:49], s[36:37]
    s_mov_b32 s87, 0
    s_mov_b32 s84, 0xfff98000
    s_mov_b32 s87, 0x80000000
    s_barrier
    s_sub_u32 s62, s23, 0x900000
    buffer_load_dwordx4 v[232:235], v2, s[32:35], s62 offen nt
    buffer_load_dword v240, v2, s[32:35], s62 offen offset:16
    buffer_load_dwordx4 v[236:239], v2, s[32:35], s62 offen offset:1024 nt
    buffer_load_dword v241, v2, s[32:35], s62 offen offset:1040
    s_add_u32 m0, s80, 0
    s_nop 0
    buffer_load_dwordx4 v12, s[28:31], s81 offen lds
    buffer_load_dwordx4 v13, s[28:31], s81 offen offset:1024 lds
    buffer_load_dwordx4 v14, s[28:31], s81 offen offset:2048 lds
    s_waitcnt vmcnt(7)
    buffer_store_dword v28, v3, s[36:39], s18 offen sc1
    buffer_load_dwordx4 v15, s[28:31], s81 offen offset:3072 lds
    s_add_u32 m0, s80, 4096
    s_add_u32 s81, s81, 32768
    buffer_load_dwordx4 v12, s[28:31], s81 offen lds
    buffer_load_dwordx4 v13, s[28:31], s81 offen offset:1024 lds
    buffer_load_dwordx4 v14, s[28:31], s81 offen offset:2048 lds
    buffer_load_dwordx4 v15, s[28:31], s81 offen offset:3072 lds
    s_cmp_eq_u32 s83, 6
    s_cselect_b32 s96, s84, 0x8000
    s_add_u32 m0, s80, 32768
    s_add_u32 s81, s81, s96
    buffer_load_dwordx4 v12, s[28:31], s81 offen lds
    buffer_load_dwordx4 v13, s[28:31], s81 offen offset:1024 lds
    buffer_load_dwordx4 v14, s[28:31], s81 offen offset:2048 lds
    buffer_load_dwordx4 v15, s[28:31], s81 offen offset:3072 lds
    s_add_u32 m0, s80, 36864
    s_add_u32 s81, s81, 32768
    buffer_load_dwordx4 v12, s[28:31], s81 offen lds
    buffer_load_dwordx4 v13, s[28:31], s81 offen offset:1024 lds
    buffer_load_dwordx4 v14, s[28:31], s81 offen offset:2048 lds
    buffer_load_dwordx4 v15, s[28:31], s81 offen offset:3072 lds
    s_cmp_eq_u32 s83, 5
    s_cselect_b32 s96, s84, 0x8000
    s_add_u32 m0, s80, 65536
    s_add_u32 s81, s81, s96
    buffer_load_dwordx4 v12, s[28:31], s81 offen lds
    buffer_load_dwordx4 v13, s[28:31], s81 offen offset:1024 lds
    buffer_load_dwordx4 v14, s[28:31], s81 offen offset:2048 lds
    buffer_load_dwordx4 v15, s[28:31], s81 offen offset:3072 lds
    s_add_u32 m0, s80, 69632
    s_add_u32 s81, s81, 32768
    buffer_load_dwordx4 v12, s[28:31], s81 offen lds
    buffer_load_dwordx4 v13, s[28:31], s81 offen offset:1024 lds
    buffer_load_dwordx4 v14, s[28:31], s81 offen offset:2048 lds
    buffer_load_dwordx4 v15, s[28:31], s81 offen offset:3072 lds
    s_mul_i32 s7, s86, 8320
    s_lshl_b32 s6, s85, 11
    s_add_u32 s7, s7, s6
    s_add_u32 s7, s7, 131104
    v_add_u32 v242, s7, v2
    s_waitcnt vmcnt(28)
    ds_write_b128 v242, v[232:235] offset:0
    v_alignbit_b32 v244, v233, v232, 16
    v_alignbit_b32 v245, v234, v233, 16
    v_alignbit_b32 v246, v235, v234, 16
    s_waitcnt vmcnt(27)
    v_alignbit_b32 v247, v240, v235, 16
    ds_write_b128 v242, v[244:247] offset:4160
    s_waitcnt vmcnt(26)
    ds_write_b128 v242, v[236:239] offset:1024
    v_alignbit_b32 v248, v237, v236, 16
    v_alignbit_b32 v249, v238, v237, 16
    v_alignbit_b32 v250, v239, v238, 16
    s_waitcnt vmcnt(25)
    v_alignbit_b32 v251, v241, v239, 16
    ds_write_b128 v242, v[248:251] offset:5184
    v_accvgpr_read_b32 v230, a248
    v_accvgpr_read_b32 v231, a249
    s_lshl_b32 s7, s86, 4
    v_lshrrev_b32 v230, s7, v230
    v_lshlrev_b32 v230, 16, v230
    v_lshlrev_b32_e64 v231, 16, v231
    v_mul_lo_u32 v231, v231, s85
    v_readfirstlane_b32 s59, v230
    s_mul_i32 s7, s5, 4160
    v_and_b32 v230, 7, v1
    v_cmp_eq_u32 vcc, 7, v230
    v_lshlrev_b32 v230, 2, v230
    s_add_u32 s7, s7, 131072
    v_cndmask_b32 v231, 0, v231, vcc
    v_add_u32 v230, s7, v230
    ds_write_b32 v230, v231
    s_mov_b64 s[24:25], s[36:37]
    s_mov_b32 s92, 0xffffa000
    s_mov_b32 s56, s58
    s_mov_b32 s57, s58
    buffer_load_dword v228, v47, s[36:39], s19 offen sc1
    s_waitcnt vmcnt(0)
    v_cmp_ne_u32 vcc, s58, v228
    s_nop 1
    s_cbranch_vccnz L_rare5
L_back5:
    s_mov_b32 s40, 0
    s_mov_b32 s26, 12582912
    buffer_load_dwordx4 v[220:223], v2, s[24:27], s20 offen sc1
    buffer_load_dwordx4 v[224:227], v2, s[24:27], s20 offen offset:1024 sc1
    s_waitcnt vmcnt(0) lgkmcnt(0)
    s_branch L_join
L_rareN:
    s_mov_b32 s96, 0
L_rlN:
    s_sleep 2
    buffer_load_dword v28, off, s[48:51], 0 sc1
    s_waitcnt vmcnt(0)
    v_readfirstlane_b32 s58, v28
    s_nop 1
    s_cmp_lg_u32 s58, 0
    s_cbranch_scc1 L_backN
    s_add_u32 s96, s96, 1
    s_cmp_lt_u32 s96, 0x4000
    s_cbranch_scc1 L_rlN
    s_branch L_backN
L_rare0:
    s_mov_b32 s96, 0
L_rl0:
    s_sleep 1
    buffer_load_dwordx2 v[212:213], v29, s[36:39], s82 offen offset:0 sc1
    buffer_load_dwordx2 v[214:215], v29, s[36:39], s82 offen offset:512 sc1
    s_waitcnt vmcnt(0)
    v_xor_b32 v63, s58, v213
    v_xor_b32 v215, s58, v215
    v_or_b32 v63, v63, v215
    v_cmp_ne_u32 vcc, 0, v63
    s_nop 1
    s_cbranch_vccz L_back0
    s_add_u32 s96, s96, 1
    s_cmp_lt_u32 s96, 0x4000
    s_cbranch_scc1 L_rl0
    s_branch L_back0
L_rare1:
    s_mov_b32 s96, 0
L_rl1:
    s_load_dwordx4 s[8:11], s[36:37], s22 glc
    s_load_dwordx4 s[88:91], s[36:37], s22 offset:16 glc
    s_waitcnt lgkmcnt(0)
    s_mov_b32 s91, s90
    s_xor_b64 s[8:9], s[8:9], s[56:57]
    s_xor_b64 s[10:11], s[10:11], s[56:57]
    s_or_b64 s[8:9], s[8:9], s[10:11]
    s_xor_b64 s[88:89], s[88:89], s[56:57]
    s_or_b64 s[8:9], s[8:9], s[88:89]
    s_xor_b64 s[90:91], s[90:91], s[56:57]
    s_or_b64 s[8:9], s[8:9], s[90:91]
    s_cbranch_scc0 L_back1
    s_sleep 1
    s_add_u32 s96, s96, 1
    s_cmp_lt_u32 s96, 0x4000
    s_cbranch_scc1 L_rl1
    s_branch L_back1
L_rare2:
    s_mov_b32 s96, 0
    s_waitcnt vmcnt(0) lgkmcnt(0)
    s_mov_b32 s50, 12582912
    s_mov_b32 s87, 0x80000000
    buffer_store_dword v28, v3, s[48:51], s21 offen sc1
L_rl2:
    buffer_load_dword v228, v47, s[36:39], s19 offen sc1
    s_waitcnt vmcnt(0)
    v_cmp_ne_u32 vcc, s58, v228
    s_nop 1
    s_cbranch_vccz L_ok2
    s_sleep 1
    s_add_u32 s96, s96, 1
    s_cmp_lt_u32 s96, 0x4000
    s_cbranch_scc1 L_rl2
L_ok2:
    s_mov_b32 s26, 12582912
    buffer_load_dwordx4 v[220:223], v2, s[24:27], s20 offen sc1
    buffer_load_dwordx4 v[224:227], v2, s[24:27], s20 offen offset:1024 sc1
    s_waitcnt vmcnt(0) lgkmcnt(0)
    s_nop 4
    s_branch L_back2
L_odd:
    ds_write_b128 v44, v[64:67] offset:0
    ds_write_b128 v44, v[68:71] offset:1024
    ds_write_b128 v44, v[72:75] offset:2048
    ds_write_b128 v44, v[76:79] offset:3072
    v_and_b32 v104, 0xffff0000, v117
    v_lshlrev_b32 v105, 16, v117
    v_and_b32 v106, 0xffff0000, v116
    v_lshlrev_b32_e64 v107, 16, v116
    v_and_b32 v108, 0xffff0000, v119
    v_lshlrev_b32_e64 v109, 16, v119
    v_and_b32 v110, 0xffff0000, v118
    v_lshlrev_b32_e64 v111, 16, v118
    v_pk_fma_f32 v[96:97], v[96:97], v[120:121], v[80:81] op_sel_hi:[1,0,1]
    v_pk_fma_f32 v[98:99], v[98:99], v[120:121], v[82:83] op_sel_hi:[1,0,1]
    v_pk_fma_f32 v[100:101], v[100:101], v[120:121], v[84:85] op_sel_hi:[1,0,1]
    v_pk_fma_f32 v[102:103], v[102:103], v[120:121], v[86:87] op_sel_hi:[1,0,1]
    v_pk_fma_f32 v[104:105], v[104:105], v[120:121], v[88:89] op_sel_hi:[1,0,1]
    v_pk_fma_f32 v[106:107], v[106:107], v[120:121], v[90:91] op_sel_hi:[1,0,1]
    v_pk_fma_f32 v[108:109], v[108:109], v[120:121], v[92:93] op_sel_hi:[1,0,1]
    v_pk_fma_f32 v[110:111], v[110:111], v[120:121], v[94:95] op_sel_hi:[1,0,1]
    s_branch L_oddback
L_rare3:
    s_mov_b32 s96, 0
L_rl3:
    s_sleep 1
    buffer_load_dwordx2 v[8:9], v29, s[36:39], s61 offen sc1
    s_waitcnt vmcnt(0)
    v_cmp_ne_u32 vcc, s58, v9
    s_nop 1
    s_cbranch_vccz L_back3
    s_add_u32 s96, s96, 1
    s_cmp_lt_u32 s96, 0x4000
    s_cbranch_scc1 L_rl3
    s_branch L_back3
L_rare4:
    s_mov_b32 s96, 0
    s_waitcnt vmcnt(0) lgkmcnt(0)
L_rl4:
    buffer_load_dword v5, v49, s[36:39], s53 offen sc1
    s_waitcnt vmcnt(0)
    v_cmp_ne_u32 vcc, s58, v5
    s_nop 1
    s_cbranch_vccz L_ok4
    s_sleep 1
    s_add_u32 s96, s96, 1
    s_cmp_lt_u32 s96, 0x4000
    s_cbranch_scc1 L_rl4
L_ok4:
    s_mov_b32 s26, 12582912
    s_add_u32 s6, s55, 65536
    buffer_load_dwordx4 v[192:195], v51, s[24:27], s55 offen sc1
    buffer_load_dwordx4 v[196:199], v51, s[24:27], s6 offen sc1
    s_waitcnt vmcnt(1)
    ds_write_b128 v54, v[192:195]
    s_waitcnt vmcnt(0)
    ds_write_b128 v54, v[196:199] offset:1024
    ds_read_b64_tr_b16 v[16:17], v55 offset:0
    ds_read_b64_tr_b16 v[18:19], v55 offset:512
    ds_read_b64_tr_b16 v[20:21], v55 offset:1024
    ds_read_b64_tr_b16 v[22:23], v55 offset:1536
    s_waitcnt vmcnt(0) lgkmcnt(0)
    s_nop 4
    s_branch L_back4
L_rareM:
    s_mov_b32 s96, 0
L_rlM:
    s_sleep 2
    buffer_load_dword v28, off, s[48:51], 0 sc1
    s_waitcnt vmcnt(0)
    v_readfirstlane_b32 s58, v28
    s_nop 1
    s_cmp_lg_u32 s58, 0
    s_cbranch_scc1 L_backM
    s_add_u32 s96, s96, 1
    s_cmp_lt_u32 s96, 0x4000
    s_cbranch_scc1 L_rlM
    s_branch L_backM
L_rare5:
    s_mov_b32 s96, 0
L_rl5:
    s_sleep 1
    buffer_load_dword v228, v47, s[36:39], s19 offen sc1
    s_waitcnt vmcnt(0)
    v_cmp_ne_u32 vcc, s58, v228
    s_nop 1
    s_cbranch_vccz L_back5
    s_add_u32 s96, s96, 1
    s_cmp_lt_u32 s96, 0x4000
    s_cbranch_scc1 L_rl5
    s_branch L_back5
L_codeend:
.section .rodata,"a"
.p2align 6
.amdhsa_kernel recurrent_scan__ssm_conv_h3__dense_activation_silu__prompt_kernel
  .amdhsa_next_free_vgpr 512
  .amdhsa_next_free_sgpr 102
  .amdhsa_accum_offset 256
  .amdhsa_group_segment_fixed_size 0
  .amdhsa_kernarg_size 96
  .amdhsa_user_sgpr_count 2
  .amdhsa_user_sgpr_kernarg_segment_ptr 1
  .amdhsa_system_sgpr_workgroup_id_x 1
.end_amdhsa_kernel
```
